```python
import torch

def _softmax(x, axis=-1):
    return torch.softmax(x, dim=axis)

def _gelu(x):
    return torch.nn.functional.gelu(x, approximate='tanh')

def _silu(x):
    return torch.nn.functional.silu(x)

def _sigmoid(x):
    return torch.sigmoid(x)

def _layernorm(x, axis=-1, eps=1e-05):
    m = x.mean(dim=axis, keepdim=True)
    v = x.var(dim=axis, keepdim=True, unbiased=False)
    return (x - m) / torch.sqrt(v + eps)

def _scatter_add(tgt, idx, src, axis=0):
    return tgt.clone().index_add_(axis, idx, src)

def _segment_sum(src, seg, n):
    out = torch.zeros((n,) + src.shape[1:], dtype=src.dtype)
    return out.index_add_(0, seg, src)

def _pad(x, pw):
    flat = tuple((v for pair in reversed(pw) for v in pair))
    return torch.nn.functional.pad(x, flat)
kernel_name = 'adaLN_cond__sliding_block_cached__swiglu_ffn__decode'

def setup_inputs():

    _w = lambda a: (lambda t: t.to(torch.bfloat16) if t.is_floating_point() else t)(torch.as_tensor(a))

    def _A_setup():
        B, Sq, D = (2, 1, 512)
        Hq, Hkv, Sk, Dh = (32, 8, 32768, 128)
        assert Hq % Hkv == 0, (Hq, Hkv)
        return {'x': _w((lambda *s: torch.randn(*s, dtype=torch.bfloat16) * 0.05)(B, Sq, D)), 'k_cache': _w((lambda *s: torch.randn(*s, dtype=torch.bfloat16) * 3.2)(B, Hkv, Sk, Dh)), 'v_cache': _w((lambda *s: torch.randn(*s, dtype=torch.bfloat16) * 0.4)(B, Hkv, Sk, Dh)), 'wq': _w((lambda *s: torch.randn(*s, dtype=torch.bfloat16) * 3.2)(D, Hq * Dh) * D ** (-0.5)), 'wo': _w((lambda *s: torch.randn(*s, dtype=torch.bfloat16) * 0.4)(Hq * Dh, D) * (Hq * Dh) ** (-0.5))}
    _A_in = _A_setup()

    def _B_setup():
        B, S, D, F = (2, 1, 512, 1792)
        return {'x': _w((lambda *s: torch.randn(*s, dtype=torch.bfloat16) * 0.05)(B, S, D)), 'w_gate': _w((lambda *s: torch.randn(*s, dtype=torch.bfloat16) * 0.05)(D, F)), 'w_up': _w((lambda *s: torch.randn(*s, dtype=torch.bfloat16) * 0.05)(D, F)), 'w_down': _w((lambda *s: torch.randn(*s, dtype=torch.bfloat16) * 0.05)(F, D))}
    _B_in = _B_setup()
    return {'A_x': _A_in['x'], 'A_k_cache': _A_in['k_cache'], 'A_v_cache': _A_in['v_cache'], 'A_wq': _A_in['wq'], 'A_wo': _A_in['wo'], 'B_x': _B_in['x'], 'B_w_gate': _B_in['w_gate'], 'B_w_up': _B_in['w_up'], 'B_w_down': _B_in['w_down'], 'c': _w((lambda *s: torch.randn(*s, dtype=torch.bfloat16) * 0.2)(2, 512) * 8.0), 'w_mod': _w((lambda *s: torch.randn(*s, dtype=torch.bfloat16) * 0.2)(512, 6 * 512) * 512 ** (-0.5) * 8.0)}

def reference(A_x, A_k_cache, A_v_cache, A_wq, A_wo, B_x, B_w_gate, B_w_up, B_w_down, c, w_mod):

    def _A_ref(x, k_cache, v_cache, wq, wo):
        B, Sq, D = x.shape
        Hq, Dh = (32, 128)
        Hkv, Sk = (k_cache.shape[1], k_cache.shape[2])
        W = min(4096, max(256, Sk // 4))
        rep = Hq // Hkv
        q = (lambda x, *d: x.permute(*d))((x @ wq).reshape(B, Sq, Hq, Dh), 0, 2, 1, 3)
        k = (lambda x, n, axis: torch.repeat_interleave(x, n, dim=axis))(k_cache[:, :, Sk - W:, :], rep, axis=1)
        v = (lambda x, n, axis: torch.repeat_interleave(x, n, dim=axis))(v_cache[:, :, Sk - W:, :], rep, axis=1)
        scores = torch.einsum('bhqd,bhkd->bhqk', q, k) * Dh ** (-0.5)
        p = _softmax(scores, axis=-1)
        o = torch.einsum('bhqk,bhkd->bhqd', p, v)
        return (lambda x, *d: x.permute(*d))(o, 0, 2, 1, 3).reshape(B, Sq, Hq * Dh) @ wo

    def _B_ref(x, w_gate, w_up, w_down):
        g = _silu(x @ w_gate)
        u = x @ w_up
        return g * u @ w_down
    x = A_x
    mod = (_silu(c) @ w_mod).reshape(c.shape[0], 6, 1, -1)
    sa, ca, ga, sb, cb, gb = (mod[:, 0].clone(), mod[:, 1].clone(), mod[:, 2].clone(), mod[:, 3].clone(), mod[:, 4].clone(), mod[:, 5].clone())
    h = _layernorm(x, axis=-1) * (1 + ca) + sa
    x = x + ga * _A_ref(h, A_k_cache, A_v_cache, A_wq, A_wo)
    h = _layernorm(x, axis=-1) * (1 + cb) + sb
    x = x + gb * _B_ref(h, B_w_gate, B_w_up, B_w_down)
    return x
```

```asm
; @launch grid=(256,1,1) block=(768,1,1) lds=163840
.amdgcn_target "amdgcn-amd-amdhsa--gfx950"
.text
.globl adaLN_cond__sliding_block_cached__swiglu_ffn__decode_kernel
.p2align 8
.type adaLN_cond__sliding_block_cached__swiglu_ffn__decode_kernel,@function
adaLN_cond__sliding_block_cached__swiglu_ffn__decode_kernel:
    s_cmp_ge_u32 s2, 256
    s_cbranch_scc1 L_end
    s_load_dwordx16 s[16:31], s[0:1], 0
    s_load_dwordx8 s[32:39], s[0:1], 64
    s_load_dwordx4 s[40:43], s[0:1], 96
    s_bfe_u32 s66, s2, 0x30003
    s_cmp_lg_u32 s66, 7
    s_cbranch_scc1 L_nopf
    s_getpc_b64 s[66:67]
L_pc:
    v_lshlrev_b32 v7, 7, v0
    v_cmp_gt_u32 vcc, (L_codeend-L_pc-4)/128, v0
    s_nop 0
    s_and_saveexec_b64 s[68:69], vcc
    s_cbranch_execz L_nopf
    global_load_dword v166, v7, s[66:67]
L_nopf:
    s_mov_b64 exec, -1
    v_lshrrev_b32 v1, 6, v0
    v_and_b32 v0, 63, v0
    v_readfirstlane_b32 s3, v1
    s_and_b32 s4, s2, 7
    s_lshr_b32 s5, s2, 3
    s_and_b32 s6, s5, 15
    s_lshr_b32 s7, s5, 4
    s_sub_u32 s12, s3, 1
    s_cmp_lt_u32 s4, 4
    s_cselect_b32 s99, 8, 4
    v_mov_b32 v4, 0
    s_cmp_lg_u32 s3, 0
    s_cbranch_scc1 L_ninit
    s_cmp_lt_u32 s6, 12
    s_cselect_b32 s14, 2, 2
    s_cmp_lt_u32 s6, s99
    s_cselect_b32 s14, 2, s14
    s_cmp_lt_u32 s4, 4
    s_cselect_b32 s15, 0, 0
    s_add_u32 s14, s14, s15
    v_lshlrev_b32 v2, 2, v0
    v_mov_b32 v9, 0xff800000
    v_mov_b32 v8, 0
    v_writelane_b32 v8, s14, 4
    ds_write_b32 v2, v9 offset:1280
    ds_write_b32 v2, v4 offset:1536
    ds_write_b32 v2, v8
L_ninit:
    s_cmp_ge_u32 s6, 12
    s_cbranch_scc1 L_noimg0
    s_cmp_ge_u32 s12, 8
    s_cbranch_scc1 L_noimg0
    s_and_b32 s14, s2, 0x64
    s_cmp_eq_u32 s14, 0x24
    s_cbranch_scc1 L_noimg0
    s_and_b32 s14, s6, 3
    s_lshl_b32 s15, s7, 2
    s_add_u32 s15, s15, s14
    s_lshl_b32 s61, s12, 13
    s_mov_b32 s59, 0x20000
    s_cmp_lt_u32 s6, 4
    s_cbranch_scc1 L_imQ
    s_cmp_ge_u32 s6, 8
    s_cbranch_scc1 L_imW
    s_movk_i32 s68, 6144
    s_mov_b32 s69, 49152
    s_mov_b32 s58, 3145728
    s_mov_b32 s62, 20
    s_and_b32 s60, s4, 3
    s_lshl_b32 s60, s60, 3
    s_add_u32 s60, s60, s15
    s_lshr_b32 s63, s60, 4
    s_lshl_b32 s63, s63, 3
    s_add_u32 s63, s63, s12
    s_mul_i32 s63, s63, 196608
    s_and_b32 s60, s60, 15
    s_lshl_b32 s60, s60, 7
    s_lshl_b32 s61, s12, 12
    s_branch L_imgo
L_imW:
    s_movk_i32 s68, 1024
    s_movk_i32 s69, 8192
    s_mov_b32 s58, 0x400000
    s_mov_b32 s62, 8
    s_lshl_b32 s60, s15, 7
    s_lshl_b32 s63, s4, 3
    s_add_u32 s63, s63, s12
    s_lshl_b32 s63, s63, 16
    s_branch L_imgo
L_imQ:
    s_movk_i32 s68, 8192
    s_mov_b32 s69, 65536
    s_mov_b32 s58, 0x400000
    s_mov_b32 s62, 6
    s_lshl_b32 s60, s4, 3
    s_add_u32 s60, s60, s15
    s_lshl_b32 s60, s60, 7
    s_lshl_b32 s63, s12, 19
L_imgo:
    s_add_u32 s60, s60, s63
    s_add_u32 s61, s61, 0x18000
    v_lshrrev_b32 v2, 3, v0
    v_mul_u32_u24 v2, s68, v2
    v_and_b32 v3, 7, v0
    v_bfe_u32 v6, v0, 4, 1
    v_lshlrev_b32 v6, 1, v6
    v_xor_b32 v3, v3, v6
    v_lshl_add_u32 v8, v3, 4, v2
    v_xor_b32 v9, 64, v8
    s_mov_b32 m0, s61
    s_cmp_eq_u32 s62, 6
    s_waitcnt lgkmcnt(0)
    s_cselect_b64 s[56:57], s[22:23], s[24:25]
    s_cmp_eq_u32 s62, 20
    s_cselect_b64 s[56:57], s[36:37], s[56:57]
    s_and_b32 s57, s57, 0xffff
    buffer_load_dwordx4 v8, s[56:59], s60 offen nt lds
    s_add_u32 m0, s61, 1024
    s_add_u32 s60, s60, s69
    buffer_load_dwordx4 v8, s[56:59], s60 offen nt lds
    s_add_u32 m0, s61, 2048
    s_add_u32 s60, s60, s69
    s_barrier
    buffer_load_dwordx4 v9, s[56:59], s60 offen nt lds
    s_add_u32 m0, s61, 3072
    s_add_u32 s60, s60, s69
    buffer_load_dwordx4 v9, s[56:59], s60 offen nt lds
    s_add_u32 m0, s61, 4096
    s_add_u32 s60, s60, s69
    s_and_b32 s14, s2, 0x64
    s_cmp_eq_u32 s14, 0x20
    s_cbranch_scc1 L_noimg
    buffer_load_dwordx4 v8, s[56:59], s60 offen nt lds
    s_add_u32 m0, s61, 5120
    s_add_u32 s60, s60, s69
    buffer_load_dwordx4 v8, s[56:59], s60 offen nt lds
    s_add_u32 m0, s61, 6144
    s_add_u32 s60, s60, s69
    buffer_load_dwordx4 v9, s[56:59], s60 offen nt lds
    s_add_u32 m0, s61, 7168
    s_add_u32 s60, s60, s69
    buffer_load_dwordx4 v9, s[56:59], s60 offen nt lds
    s_branch L_noimg
L_noimg0:
    s_cmp_lg_u32 s3, 0
    s_cbranch_scc1 L_nb0
    s_waitcnt lgkmcnt(0)
L_nb0:
    s_barrier
L_noimg:
    s_cmp_lt_u32 s4, 4
    s_cbranch_scc0 L_clsB
    s_mov_b32 s64, 0x66775666
    s_mov_b32 s65, 0x9aa99bba
    s_mov_b32 s60, 0x120c0600
    s_mov_b32 s61, 0x2b251e17
    s_mov_b32 s62, 0x51463b31
    s_mov_b32 s63, 0x776d635a
    s_cmp_eq_u32 s7, 0
    s_cbranch_scc1 L_clsA
    s_mov_b32 s64, 0x57776666
    s_mov_b32 s65, 0x78a9bbbb
    s_mov_b32 s60, 0x120c0600
    s_mov_b32 s61, 0x2d261f18
    s_mov_b32 s62, 0x53483d32
    s_mov_b32 s63, 0x7971675e
    s_branch L_clsA
L_clsB:
    s_mov_b32 s64, 0xbbbb4665
    s_mov_b32 s65, 0xb8756989
    s_mov_b32 s60, 0x110b0500
    s_mov_b32 s61, 0x362b2015
    s_mov_b32 s62, 0x5b524a41
    s_mov_b32 s63, 0x756d6661
    s_cmp_eq_u32 s7, 0
    s_cbranch_scc1 L_clsA
    s_mov_b32 s64, 0xbbbb5655
    s_mov_b32 s65, 0xb7659889
    s_mov_b32 s60, 0x100a0500
    s_mov_b32 s61, 0x362b2015
    s_mov_b32 s62, 0x5a524a41
    s_mov_b32 s63, 0x756e6863
L_clsA:
    s_lshl_b32 s14, s6, 2
    s_lshr_b64 s[64:65], s[64:65], s14
    s_and_b32 s11, s64, 15
    s_cmp_lt_u32 s6, 8
    s_cselect_b64 s[60:61], s[60:61], s[62:63]
    s_lshl_b32 s14, s6, 3
    s_lshr_b64 s[60:61], s[60:61], s14
    s_and_b32 s13, s60, 255
    s_sub_u32 s98, s12, s11
    s_add_u32 s14, s98, 11
    s_cmp_lt_u32 s12, s11
    s_cselect_b32 s98, s14, s98
    v_lshlrev_b32 v1, 4, v0
    v_mov_b32 v5, 1
    s_mov_b32 s74, 0xffff0000
    s_mov_b32 s46, 0x20000000
    s_mov_b32 s47, 0x20000
    s_cmp_lt_u32 s12, s11
    s_cbranch_scc0 L_pn
    s_lshl_b32 s60, s7, 3
    s_add_u32 s60, s60, s4
    s_lshl_b32 s60, s60, 23
    s_add_u32 s60, s60, 7340032
    s_lshl_b32 s61, s13, 1
    s_add_u32 s61, s61, s12
    s_lshl_b32 s62, s61, 12
    s_add_u32 s62, s62, s60
    s_lshl_b32 s61, s11, 12
    s_add_u32 s63, s62, s61
    v_lshrrev_b32 v3, 4, v0
    v_lshlrev_b32 v2, 6, v3
    v_xor_b32 v160, v1, v2
    v_xor_b32 v161, 16, v160
    v_xor_b32 v162, 32, v160
    v_xor_b32 v163, 48, v160
    s_and_b32 s70, s12, 7
    s_lshl_b32 s70, s70, 13
    s_add_u32 s70, s70, 30720
    s_mov_b32 m0, s70
    s_mov_b32 s50, 0x8000000
    s_mov_b32 s51, 0x20000
    s_mov_b32 s54, 0x8000000
    s_mov_b32 s55, 0x20000
    s_waitcnt lgkmcnt(0)
    s_mov_b32 s48, s18
    s_and_b32 s49, s19, 0xffff
    s_mov_b32 s52, s20
    s_and_b32 s53, s21, 0xffff
    s_lshl_b32 s71, s12, 1
    s_add_i32 s71, s71, -1
    s_cmp_lt_u32 s6, s99
    s_cbranch_scc1 L_kvE_1
    s_and_b32 s14, s6, 12
    s_cmp_eq_u32 s14, 8
    s_cselect_b32 s78, 0, 2
    s_cmp_gt_i32 s71, s78
    s_cbranch_scc1 L_kv0_2
    buffer_load_dwordx4 v160, s[48:51], s62 offen offset:0 nt lds
    buffer_load_dwordx4 v161, s[48:51], s62 offen offset:1024 nt lds
    buffer_load_dwordx4 v162, s[48:51], s62 offen offset:2048 nt lds
    buffer_load_dwordx4 v163, s[48:51], s62 offen offset:3072 nt lds
    s_load_dword s8, s[42:43], 0
    s_load_dword s100, s[42:43], 0xffe00
    s_mov_b32 s44, s42
    s_and_b32 s45, s43, 0xffff
    s_add_u32 m0, s70, 4096
    s_nop 0
    buffer_load_dwordx4 v160, s[48:51], s63 offen offset:0 nt lds
    buffer_load_dwordx4 v161, s[48:51], s63 offen offset:1024 nt lds
    buffer_load_dwordx4 v162, s[48:51], s63 offen offset:2048 nt lds
    buffer_load_dwordx4 v163, s[48:51], s63 offen offset:3072 nt lds
    buffer_load_dwordx4 v[40:43], v1, s[52:55], s62 offen offset:0 nt
    buffer_load_dwordx4 v[44:47], v1, s[52:55], s62 offen offset:1024 nt
    buffer_load_dwordx4 v[48:51], v1, s[52:55], s62 offen offset:2048 nt
    buffer_load_dwordx4 v[52:55], v1, s[52:55], s62 offen offset:3072 nt
    buffer_load_dwordx4 v[56:59], v1, s[52:55], s63 offen offset:0 nt
    buffer_load_dwordx4 v[60:63], v1, s[52:55], s63 offen offset:1024 nt
    buffer_load_dwordx4 v[64:67], v1, s[52:55], s63 offen offset:2048 nt
    buffer_load_dwordx4 v[68:71], v1, s[52:55], s63 offen offset:3072 nt
    s_waitcnt vmcnt(16)
    s_mov_b64 exec, 1
    ds_add_u32 v4, v5 offset:28
    s_mov_b64 exec, -1
    s_branch L_kvG2_6
L_kvE_1:
    s_load_dword s8, s[42:43], 0
    s_load_dword s100, s[42:43], 0xffe00
    s_mov_b32 s44, s42
    s_and_b32 s45, s43, 0xffff
    s_cmp_ge_u32 s12, 8
    s_cbranch_scc1 L_kvE2_7
    s_waitcnt vmcnt(0)
    s_mov_b64 exec, 1
    ds_add_u32 v4, v5 offset:28
    s_mov_b64 exec, -1
L_kvE2_7:
    s_mov_b32 s10, 0
L_fw_10:
    ds_read_b32 v6, v4 offset:72
    s_add_u32 s10, s10, 1
    s_cmp_gt_u32 s10, 800000
    s_cbranch_scc1 L_exit
    s_waitcnt lgkmcnt(0)
    v_cmp_le_u32 vcc, 4, v6
    s_cbranch_vccnz L_fd_11
    s_sleep 2
    s_branch L_fw_10
L_fd_11:
    s_branch L_kvq2_4
L_kv0_2:
    s_load_dword s8, s[42:43], 0
    s_load_dword s100, s[42:43], 0xffe00
    s_mov_b32 s44, s42
    s_and_b32 s45, s43, 0xffff
    s_cmp_ge_u32 s12, 8
    s_cbranch_scc1 L_kvq2_4
    s_waitcnt vmcnt(0)
    s_mov_b64 exec, 1
    ds_add_u32 v4, v5 offset:28
    s_mov_b64 exec, -1
L_kvq2_4:
    s_mov_b32 s10, 0
L_tw_13:
    ds_read_b32 v6, v4 offset:16
    s_add_u32 s10, s10, 1
    s_cmp_gt_u32 s10, 800000
    s_cbranch_scc1 L_exit
    s_waitcnt lgkmcnt(0)
    v_readfirstlane_b32 s14, v6
    s_nop 0
    s_cmp_ge_i32 s14, s71
    s_cbranch_scc1 L_tg_14
    s_sleep 1
    s_branch L_tw_13
L_tg_14:
    s_cmp_lt_u32 s12, 8
    s_cbranch_scc1 L_k8_5
    s_mov_b32 s10, 0
L_fw_15:
    ds_read_b32 v6, v4 offset:76
    s_add_u32 s10, s10, 1
    s_cmp_gt_u32 s10, 800000
    s_cbranch_scc1 L_exit
    s_waitcnt lgkmcnt(0)
    v_cmp_le_u32 vcc, 3, v6
    s_cbranch_vccnz L_fd_16
    s_sleep 2
    s_branch L_fw_15
L_fd_16:
L_k8_5:
    buffer_load_dwordx4 v160, s[48:51], s62 offen offset:0 nt lds
    buffer_load_dwordx4 v161, s[48:51], s62 offen offset:1024 nt lds
    buffer_load_dwordx4 v162, s[48:51], s62 offen offset:2048 nt lds
    buffer_load_dwordx4 v163, s[48:51], s62 offen offset:3072 nt lds
    s_add_u32 m0, s70, 4096
    s_nop 0
    buffer_load_dwordx4 v160, s[48:51], s63 offen offset:0 nt lds
    buffer_load_dwordx4 v161, s[48:51], s63 offen offset:1024 nt lds
    buffer_load_dwordx4 v162, s[48:51], s63 offen offset:2048 nt lds
    buffer_load_dwordx4 v163, s[48:51], s63 offen offset:3072 nt lds
    buffer_load_dwordx4 v[40:43], v1, s[52:55], s62 offen offset:0 nt
    buffer_load_dwordx4 v[44:47], v1, s[52:55], s62 offen offset:1024 nt
    buffer_load_dwordx4 v[48:51], v1, s[52:55], s62 offen offset:2048 nt
    buffer_load_dwordx4 v[52:55], v1, s[52:55], s62 offen offset:3072 nt
    buffer_load_dwordx4 v[56:59], v1, s[52:55], s63 offen offset:0 nt
    buffer_load_dwordx4 v[60:63], v1, s[52:55], s63 offen offset:1024 nt
    buffer_load_dwordx4 v[64:67], v1, s[52:55], s63 offen offset:2048 nt
    buffer_load_dwordx4 v[68:71], v1, s[52:55], s63 offen offset:3072 nt
L_kvG2_6:
    s_mov_b64 exec, 1
    ds_add_u32 v4, v5 offset:8
    s_mov_b64 exec, -1
L_cst:
    v_lshrrev_b32 v138, 5, v0
    v_lshlrev_b32 v138, 11, v138
    v_bfe_u32 v3, v0, 2, 1
    v_lshl_add_u32 v138, v3, 10, v138
    v_bfe_u32 v3, v0, 3, 2
    v_lshl_add_u32 v138, v3, 8, v138
    v_and_b32 v3, 3, v0
    v_lshl_add_u32 v138, v3, 2, v138
    s_lshl_b32 s77, s4, 1
    s_add_u32 s77, s77, s7
    s_lshl_b32 s77, s77, 14
    s_add_u32 s77, s77, 0x20000
    s_lshl_b32 s14, s12, 12
    s_add_u32 s77, s77, s14
    s_lshl_b32 s14, s6, 4
    s_add_u32 s77, s77, s14
    s_mov_b32 s72, 0x05040100
    s_mov_b32 s73, 0x07060302
    v_bfe_u32 v133, v0, 2, 2
    v_lshlrev_b32 v132, 8, v133
    v_lshrrev_b32 v139, 4, v0
    v_lshl_add_u32 v132, v139, 4, v132
    s_lshl_b32 s14, s98, 2
    v_lshl_add_u32 v134, v133, 6, s14
    v_and_b32 v139, 15, v0
    s_lshl_b32 s14, s12, 6
    v_lshl_add_u32 v139, v139, 2, s14
    s_mov_b32 s75, 0x3db504f3
    s_mov_b32 s76, 0x3fb8aa3b
    s_cmp_ge_u32 s98, 9
    s_cselect_b32 s14, 88, 0
    v_mov_b32 v137, s14
    s_lshl_b32 s14, s98, 11
    s_add_u32 s14, s14, 8192
    v_add_u32 v140, 0, v0
    v_and_b32 v140, 63, v140
    v_lshl_add_u32 v140, v140, 2, s14
    v_add_u32 v141, 8, v0
    v_and_b32 v141, 63, v141
    v_lshl_add_u32 v141, v141, 2, s14
    v_add_u32 v142, 16, v0
    v_and_b32 v142, 63, v142
    v_lshl_add_u32 v142, v142, 2, s14
    v_add_u32 v143, 24, v0
    v_and_b32 v143, 63, v143
    v_lshl_add_u32 v143, v143, 2, s14
    v_and_b32 v3, 3, v0
    v_lshrrev_b32 v133, 2, v0
    v_lshl_add_u32 v133, v3, 3, v133
    s_lshl_b32 s14, s12, 4
    v_add_u32 v133, s14, v133
    v_and_b32 v133, 63, v133
    v_lshlrev_b32 v133, 2, v133
    v_lshl_add_u32 v133, v3, 9, v133
    v_add_u32 v133, 8192, v133
    s_cmp_ge_u32 s12, s11
    s_cbranch_scc1 L_nwp
    s_waitcnt vmcnt(8)
    s_mov_b64 exec, 1
    ds_add_u32 v4, v5 offset:16
    s_mov_b64 exec, -1
    v_and_b32 v2, 3, v0
    v_lshlrev_b32 v2, 10, v2
    v_bfe_u32 v3, v0, 2, 2
    v_lshl_add_u32 v2, v3, 8, v2
    v_lshrrev_b32 v3, 4, v0
    v_xor_b32 v3, v3, v0
    v_and_b32 v3, 15, v3
    v_lshl_add_u32 v2, v3, 4, v2
    v_add_u32 v160, s70, v2
    v_xor_b32 v161, 64, v160
    v_xor_b32 v162, 128, v160
    v_xor_b32 v163, 192, v160
    ds_read_b128 v[8:11], v160 offset:0
    ds_read_b128 v[12:15], v161 offset:0
    ds_read_b128 v[16:19], v162 offset:0
    ds_read_b128 v[20:23], v163 offset:0
    ds_read_b128 v[24:27], v160 offset:4096
    ds_read_b128 v[28:31], v161 offset:4096
    ds_read_b128 v[32:35], v162 offset:4096
    ds_read_b128 v[36:39], v163 offset:4096
    ds_read_b32 v6, v4 offset:20
    s_waitcnt lgkmcnt(0)
    s_mov_b64 exec, 1
    ds_add_u32 v4, v5 offset:12
    s_mov_b64 exec, -1
    s_cmp_ge_u32 s12, 3
    s_cbranch_scc1 L_k3_17
    s_mov_b64 exec, 1
    ds_add_u32 v4, v5 offset:76
    s_mov_b64 exec, -1
L_k3_17:
    s_mov_b32 s79, 1
    v_cmp_ne_u32 vcc, 0, v6
    s_cbranch_vccnz L_qk
    s_mov_b32 s79, 0
L_retA:
    s_waitcnt vmcnt(6)
    v_perm_b32 v72, v44, v40, s72
    v_perm_b32 v76, v44, v40, s73
    v_perm_b32 v80, v45, v41, s72
    v_perm_b32 v84, v45, v41, s73
    v_perm_b32 v88, v46, v42, s72
    v_perm_b32 v92, v46, v42, s73
    v_perm_b32 v96, v47, v43, s72
    v_perm_b32 v100, v47, v43, s73
    s_waitcnt vmcnt(4)
    v_perm_b32 v73, v52, v48, s72
    v_perm_b32 v77, v52, v48, s73
    v_perm_b32 v81, v53, v49, s72
    v_perm_b32 v85, v53, v49, s73
    v_perm_b32 v89, v54, v50, s72
    v_perm_b32 v93, v54, v50, s73
    v_perm_b32 v97, v55, v51, s72
    v_perm_b32 v101, v55, v51, s73
    s_waitcnt vmcnt(2)
    v_perm_b32 v74, v60, v56, s72
    v_perm_b32 v78, v60, v56, s73
    v_perm_b32 v82, v61, v57, s72
    v_perm_b32 v86, v61, v57, s73
    v_perm_b32 v90, v62, v58, s72
    v_perm_b32 v94, v62, v58, s73
    v_perm_b32 v98, v63, v59, s72
    v_perm_b32 v102, v63, v59, s73
    s_waitcnt vmcnt(0)
    s_mov_b64 exec, 1
    ds_add_u32 v4, v5 offset:16
    s_mov_b64 exec, -1
    v_perm_b32 v75, v68, v64, s72
    v_perm_b32 v79, v68, v64, s73
    v_perm_b32 v83, v69, v65, s72
    v_perm_b32 v87, v69, v65, s73
    v_perm_b32 v91, v70, v66, s72
    v_perm_b32 v95, v70, v66, s73
    v_perm_b32 v99, v71, v67, s72
    v_perm_b32 v103, v71, v67, s73
    s_cmp_eq_u32 s79, 1
    s_cbranch_scc1 L_qkd
L_qk:
    s_mov_b32 s10, 0
L_fw_18:
    ds_read_b32 v6, v4 offset:20
    ds_read_b128 v[104:107], v132 offset:256
    ds_read_b128 v[108:111], v132 offset:320
    ds_read_b128 v[112:115], v132 offset:384
    ds_read_b128 v[116:119], v132 offset:448
    s_add_u32 s10, s10, 1
    s_cmp_gt_u32 s10, 800000
    s_cbranch_scc1 L_exit
    s_waitcnt lgkmcnt(0)
    v_cmp_le_u32 vcc, 1, v6
    s_cbranch_vccnz L_fd_19
    s_sleep 1
    s_branch L_fw_18
L_fd_19:
    v_mfma_f32_16x16x32_bf16 v[120:123], v[8:11], v[104:107], 0
    v_mfma_f32_16x16x32_bf16 v[124:127], v[24:27], v[104:107], 0
    v_mfma_f32_16x16x32_bf16 v[120:123], v[12:15], v[108:111], v[120:123]
    v_mfma_f32_16x16x32_bf16 v[124:127], v[28:31], v[108:111], v[124:127]
    v_mfma_f32_16x16x32_bf16 v[120:123], v[16:19], v[112:115], v[120:123]
    v_mfma_f32_16x16x32_bf16 v[124:127], v[32:35], v[112:115], v[124:127]
    v_mfma_f32_16x16x32_bf16 v[120:123], v[20:23], v[116:119], v[120:123]
    v_mfma_f32_16x16x32_bf16 v[124:127], v[36:39], v[116:119], v[124:127]
    s_nop 6
    v_cvt_pk_bf16_f32 v128, v120, v121
    v_cvt_pk_bf16_f32 v129, v122, v123
    v_cvt_pk_bf16_f32 v130, v124, v125
    v_cvt_pk_bf16_f32 v131, v126, v127
    v_lshlrev_b32 v120, 16, v128
    v_and_b32 v121, s74, v128
    v_lshlrev_b32 v122, 16, v129
    v_and_b32 v123, s74, v129
    v_lshlrev_b32 v124, 16, v130
    v_and_b32 v125, s74, v130
    v_lshlrev_b32 v126, 16, v131
    v_and_b32 v127, s74, v131
    v_mul_f32 v120, s75, v120
    v_mul_f32 v121, s75, v121
    v_mul_f32 v122, s75, v122
    v_mul_f32 v123, s75, v123
    v_mul_f32 v124, s75, v124
    v_mul_f32 v125, s75, v125
    v_mul_f32 v126, s75, v126
    v_mul_f32 v127, s75, v127
    v_cvt_pk_bf16_f32 v128, v120, v121
    v_cvt_pk_bf16_f32 v129, v122, v123
    v_cvt_pk_bf16_f32 v130, v124, v125
    v_cvt_pk_bf16_f32 v131, v126, v127
    v_lshlrev_b32 v120, 16, v128
    v_and_b32 v121, s74, v128
    v_lshlrev_b32 v122, 16, v129
    v_and_b32 v123, s74, v129
    v_lshlrev_b32 v124, 16, v130
    v_and_b32 v125, s74, v130
    v_lshlrev_b32 v126, 16, v131
    v_and_b32 v127, s74, v131
    v_max3_f32 v135, v120, v121, v122
    v_max3_f32 v136, v123, v124, v125
    v_max3_f32 v135, v135, v126, v127
    v_max_f32 v135, v135, v136
    v_mov_b32 v136, v135
    s_nop 1
    v_permlane32_swap_b32 v135, v136
    v_max_f32 v135, v135, v136
    v_mov_b32 v136, v135
    s_nop 1
    v_permlane16_swap_b32 v135, v136
    v_max_f32 v135, v135, v136
    ds_write_b32 v134, v135 offset:1280
    v_sub_f32 v120, v120, v135
    v_sub_f32 v121, v121, v135
    v_sub_f32 v122, v122, v135
    v_sub_f32 v123, v123, v135
    v_sub_f32 v124, v124, v135
    v_sub_f32 v125, v125, v135
    v_sub_f32 v126, v126, v135
    v_sub_f32 v127, v127, v135
    v_mul_f32 v120, s76, v120
    v_mul_f32 v121, s76, v121
    v_mul_f32 v122, s76, v122
    v_mul_f32 v123, s76, v123
    v_mul_f32 v124, s76, v124
    v_mul_f32 v125, s76, v125
    v_mul_f32 v126, s76, v126
    v_mul_f32 v127, s76, v127
    v_exp_f32 v120, v120
    v_exp_f32 v121, v121
    v_exp_f32 v122, v122
    v_exp_f32 v123, v123
    v_exp_f32 v124, v124
    v_exp_f32 v125, v125
    v_exp_f32 v126, v126
    v_exp_f32 v127, v127
    v_cvt_pk_bf16_f32 v128, v120, v121
    v_cvt_pk_bf16_f32 v129, v122, v123
    v_cvt_pk_bf16_f32 v130, v124, v125
    v_cvt_pk_bf16_f32 v131, v126, v127
    v_add_f32 v135, v120, v121
    v_add_f32 v136, v122, v123
    v_add_f32 v120, v124, v125
    v_add_f32 v121, v126, v127
    v_add_f32 v135, v135, v136
    v_add_f32 v120, v120, v121
    v_add_f32 v135, v135, v120
    v_mov_b32 v136, v135
    s_nop 1
    v_permlane32_swap_b32 v135, v136
    v_add_f32 v135, v135, v136
    v_mov_b32 v136, v135
    s_nop 1
    v_permlane16_swap_b32 v135, v136
    v_add_f32 v135, v135, v136
    ds_write_b32 v134, v135 offset:1536
    s_mov_b64 exec, 1
    ds_add_u32 v4, v5 offset:0
    s_mov_b64 exec, -1
    s_cmp_eq_u32 s79, 1
    s_cbranch_scc1 L_retA
L_qkd:
    v_mfma_f32_16x16x32_bf16 v[8:11], v[128:131], v[72:75], 0
    v_mfma_f32_16x16x32_bf16 v[12:15], v[128:131], v[76:79], 0
    v_mfma_f32_16x16x32_bf16 v[16:19], v[128:131], v[80:83], 0
    v_mfma_f32_16x16x32_bf16 v[20:23], v[128:131], v[84:87], 0
    v_mfma_f32_16x16x32_bf16 v[24:27], v[128:131], v[88:91], 0
    v_mfma_f32_16x16x32_bf16 v[28:31], v[128:131], v[92:95], 0
    v_mfma_f32_16x16x32_bf16 v[32:35], v[128:131], v[96:99], 0
    v_mfma_f32_16x16x32_bf16 v[36:39], v[128:131], v[100:103], 0
    s_nop 1
    ds_write2st64_b32 v140, v8, v12 offset0:0 offset1:1
    s_nop 0
    ds_write2st64_b32 v141, v16, v20 offset0:2 offset1:3
    s_nop 0
    ds_write2st64_b32 v142, v24, v28 offset0:4 offset1:5
    s_nop 0
    ds_write2st64_b32 v143, v32, v36 offset0:6 offset1:7
    s_mov_b64 exec, 1
    ds_add_u32 v137, v5 offset:4
    s_mov_b64 exec, -1
    s_and_b32 s14, s6, 12
    s_cmp_lg_u32 s14, 8
    s_cbranch_scc1 L_nwp
    s_cmp_ge_u32 s12, 8
    s_cbranch_scc1 L_exit
    s_waitcnt lgkmcnt(0)
    v_lshrrev_b32 v2, 4, v0
    v_bfe_u32 v6, v0, 2, 2
    v_lshl_add_u32 v3, v2, 4, v6
    v_lshlrev_b32 v3, 7, v3
    v_and_b32 v6, 3, v0
    v_lshl_add_u32 v3, v6, 3, v3
    v_bfe_u32 v6, v0, 3, 2
    v_lshl_add_u32 v3, v6, 5, v3
    s_lshl_b32 s14, s12, 13
    s_add_u32 s14, s14, 0x18000
    v_add_u32 v32, s14, v3
    v_xor_b32 v33, 32, v32
    v_xor_b32 v34, 64, v32
    v_xor_b32 v35, 96, v32
    s_lshr_b32 s14, s12, 1
    s_lshl_b32 s14, s14, 6
    v_lshl_add_u32 v38, v2, 4, s14
    s_lshl_b32 s14, s4, 15
    s_add_u32 s14, s14, 0x20000
    s_lshl_b32 s15, s12, 11
    s_add_u32 s14, s14, s15
    s_add_u32 s15, s14, 16384
    s_lshl_b32 s60, s12, 9
    v_lshl_add_u32 v37, v0, 2, s60
    ds_read_b64_tr_b16 v[40:41], v32 offset:0
    ds_read_b64_tr_b16 v[42:43], v32 offset:512
    ds_read_b64_tr_b16 v[44:45], v33 offset:0
    ds_read_b64_tr_b16 v[46:47], v33 offset:512
    ds_read_b64_tr_b16 v[48:49], v34 offset:0
    ds_read_b64_tr_b16 v[50:51], v34 offset:512
    ds_read_b64_tr_b16 v[52:53], v35 offset:0
    ds_read_b64_tr_b16 v[54:55], v35 offset:512
    ds_read_b64_tr_b16 v[56:57], v32 offset:1024
    ds_read_b64_tr_b16 v[58:59], v32 offset:1536
    s_waitcnt lgkmcnt(3)
    ds_read_b64_tr_b16 v[60:61], v33 offset:1024
    ds_read_b64_tr_b16 v[62:63], v33 offset:1536
    ds_read_b64_tr_b16 v[64:65], v34 offset:1024
    ds_read_b64_tr_b16 v[66:67], v34 offset:1536
    ds_read_b64_tr_b16 v[68:69], v35 offset:1024
    ds_read_b64_tr_b16 v[70:71], v35 offset:1536
L_nwp:
    s_cmp_ge_u32 s12, 4
    s_cbranch_scc1 L_late
    s_mov_b32 s10, 0
L_fw_20:
    ds_read_b32 v6, v4 offset:24
    s_add_u32 s10, s10, 1
    s_cmp_gt_u32 s10, 800000
    s_cbranch_scc1 L_exit
    s_waitcnt lgkmcnt(0)
    v_cmp_le_u32 vcc, 1, v6
    s_cbranch_vccnz L_fd_21
    s_sleep 1
    s_branch L_fw_20
L_fd_21:
    v_readfirstlane_b32 s96, v6
    s_mov_b32 s10, 0
L_fw_22:
    ds_read_b32 v6, v4 offset:0
    ds_read_b32 v136, v139 offset:1280
    s_add_u32 s10, s10, 1
    s_cmp_gt_u32 s10, 800000
    s_cbranch_scc1 L_exit
    s_waitcnt lgkmcnt(0)
    v_cmp_le_u32 vcc, 11, v6
    s_cbranch_vccnz L_fd_23
    s_sleep 1
    s_branch L_fw_22
L_fd_23:
    v_mov_b32 v135, v136
    s_nop 1
    v_max_f32_dpp v135, v135, v135 row_ror:1 row_mask:0xf bank_mask:0xf
    s_nop 1
    v_max_f32_dpp v135, v135, v135 row_ror:2 row_mask:0xf bank_mask:0xf
    s_nop 1
    v_max_f32_dpp v135, v135, v135 row_ror:4 row_mask:0xf bank_mask:0xf
    s_nop 1
    v_max_f32_dpp v135, v135, v135 row_ror:8 row_mask:0xf bank_mask:0xf
    v_sub_f32 v135, v136, v135
    v_mul_f32 v135, s76, v135
    v_exp_f32 v135, v135
    s_mov_b32 s10, 0
L_fw_24:
    ds_read_b32 v6, v4 offset:4
    ds_read2st64_b32 v[72:73], v133 offset0:0 offset1:1
    ds_read2st64_b32 v[74:75], v133 offset0:8 offset1:9
    ds_read2st64_b32 v[76:77], v133 offset0:16 offset1:17
    ds_read2st64_b32 v[78:79], v133 offset0:24 offset1:25
    ds_read2st64_b32 v[80:81], v133 offset0:32 offset1:33
    ds_read2st64_b32 v[82:83], v133 offset0:40 offset1:41
    ds_read2st64_b32 v[84:85], v133 offset0:48 offset1:49
    ds_read2st64_b32 v[86:87], v133 offset0:56 offset1:57
    ds_read2st64_b32 v[88:89], v133 offset0:64 offset1:65
    s_add_u32 s10, s10, 1
    s_cmp_gt_u32 s10, 800000
    s_cbranch_scc1 L_exit
    s_waitcnt lgkmcnt(0)
    v_cmp_le_u32 vcc, 9, v6
    s_cbranch_vccnz L_fd_25
    s_sleep 1
    s_branch L_fw_24
L_fd_25:
    v_mul_f32_dpp v96, v135, v72 row_newbcast:0 row_mask:0xf bank_mask:0xf
    v_mul_f32_dpp v97, v135, v73 row_newbcast:0 row_mask:0xf bank_mask:0xf
    v_mul_f32_dpp v98, v135, v74 row_newbcast:1 row_mask:0xf bank_mask:0xf
    v_mul_f32_dpp v99, v135, v75 row_newbcast:1 row_mask:0xf bank_mask:0xf
    v_fmac_f32_dpp v96, v135, v76 row_newbcast:2 row_mask:0xf bank_mask:0xf
    v_fmac_f32_dpp v97, v135, v77 row_newbcast:2 row_mask:0xf bank_mask:0xf
    v_fmac_f32_dpp v98, v135, v78 row_newbcast:3 row_mask:0xf bank_mask:0xf
    v_fmac_f32_dpp v99, v135, v79 row_newbcast:3 row_mask:0xf bank_mask:0xf
    v_fmac_f32_dpp v96, v135, v80 row_newbcast:4 row_mask:0xf bank_mask:0xf
    v_fmac_f32_dpp v97, v135, v81 row_newbcast:4 row_mask:0xf bank_mask:0xf
    v_fmac_f32_dpp v98, v135, v82 row_newbcast:5 row_mask:0xf bank_mask:0xf
    v_fmac_f32_dpp v99, v135, v83 row_newbcast:5 row_mask:0xf bank_mask:0xf
    v_fmac_f32_dpp v96, v135, v84 row_newbcast:6 row_mask:0xf bank_mask:0xf
    v_fmac_f32_dpp v97, v135, v85 row_newbcast:6 row_mask:0xf bank_mask:0xf
    v_fmac_f32_dpp v98, v135, v86 row_newbcast:7 row_mask:0xf bank_mask:0xf
    v_fmac_f32_dpp v99, v135, v87 row_newbcast:7 row_mask:0xf bank_mask:0xf
    v_fmac_f32_dpp v96, v135, v88 row_newbcast:8 row_mask:0xf bank_mask:0xf
    v_fmac_f32_dpp v97, v135, v89 row_newbcast:8 row_mask:0xf bank_mask:0xf
    s_mov_b32 s10, 0
L_fw_26:
    ds_read_b32 v6, v4 offset:92
    ds_read2st64_b32 v[90:91], v133 offset0:72 offset1:73
    ds_read2st64_b32 v[92:93], v133 offset0:80 offset1:81
    s_add_u32 s10, s10, 1
    s_cmp_gt_u32 s10, 800000
    s_cbranch_scc1 L_exit
    s_waitcnt lgkmcnt(0)
    v_cmp_le_u32 vcc, 2, v6
    s_cbranch_vccnz L_fd_27
    s_branch L_fw_26
L_fd_27:
    v_fmac_f32_dpp v98, v135, v90 row_newbcast:9 row_mask:0xf bank_mask:0xf
    v_fmac_f32_dpp v99, v135, v91 row_newbcast:9 row_mask:0xf bank_mask:0xf
    v_fmac_f32_dpp v96, v135, v92 row_newbcast:10 row_mask:0xf bank_mask:0xf
    v_fmac_f32_dpp v97, v135, v93 row_newbcast:10 row_mask:0xf bank_mask:0xf
    v_pk_add_f32 v[72:73], v[96:97], v[98:99]
    v_cvt_pk_bf16_f32 v72, v72, v73
    v_min_u32 v72, -2, v72
    s_cmp_eq_u32 s96, 2
    s_cbranch_scc1 L_pl_28
    buffer_store_dword v72, v138, s[44:47], s77 offen sc1
    s_branch L_sd_29
L_pl_28:
    buffer_store_dword v72, v138, s[44:47], s77 offen
L_sd_29:
    s_mov_b64 exec, 1
    ds_add_u32 v4, v5 offset:60
    s_mov_b64 exec, -1
L_late:
    s_cmp_ge_u32 s12, 8
    s_cbranch_scc1 L_exit
    s_cmp_ge_u32 s6, 12
    s_cbranch_scc1 L_g
    s_cmp_lt_u32 s6, 8
    s_cbranch_scc1 L_exit
    s_mov_b32 s10, 0
L_fw_30:
    ds_read_b32 v6, v4 offset:60
    s_add_u32 s10, s10, 1
    s_cmp_gt_u32 s10, 800000
    s_cbranch_scc1 L_exit
    s_waitcnt lgkmcnt(0)
    v_cmp_le_u32 vcc, 1, v6
    s_cbranch_vccnz L_fd_31
    s_sleep 2
    s_branch L_fw_30
L_fd_31:
    s_mov_b32 s61, 0
    s_mov_b32 s60, 0
    s_mov_b64 s[62:63], -1
    s_mov_b64 s[64:65], -1
    s_mov_b64 s[66:67], -1
    s_mov_b64 s[68:69], -1
    s_mov_b64 s[70:71], -1
    s_mov_b64 s[72:73], -1
L_wp_32:
    s_or_b64 exec, s[62:63], 1
    buffer_load_dwordx4 v[8:11], v1, s[44:47], s14 offen offset:0 sc1
    s_or_b64 exec, s[64:65], 1
    buffer_load_dwordx4 v[12:15], v1, s[44:47], s14 offen offset:1024 sc1
    s_or_b64 exec, s[66:67], 1
    buffer_load_dwordx4 v[16:19], v1, s[44:47], s15 offen offset:0 sc1
    s_or_b64 exec, s[68:69], 1
    buffer_load_dwordx4 v[20:23], v1, s[44:47], s15 offen offset:1024 sc1
    s_mov_b64 exec, -1
    ds_read_b32 v6, v4 offset:32
    ds_read_b128 v[24:27], v38 offset:1792
    ds_read_b128 v[28:31], v38 offset:2048
    s_cmp_lg_u32 s60, 0
    s_cbranch_scc1 L_wn1_35
    s_cmp_lg_u64 s[70:71], 0
    s_cbranch_scc1 L_wn0_34
    s_mov_b32 s60, 1
    v_mfma_f32_16x16x32_bf16 v[100:103], v[8:11], v[40:43], 0
    v_mfma_f32_16x16x32_bf16 v[104:107], v[8:11], v[44:47], 0
    v_mfma_f32_16x16x32_bf16 v[108:111], v[8:11], v[48:51], 0
    v_mfma_f32_16x16x32_bf16 v[112:115], v[8:11], v[52:55], 0
    v_mfma_f32_16x16x32_bf16 v[100:103], v[12:15], v[56:59], v[100:103]
    v_mfma_f32_16x16x32_bf16 v[104:107], v[12:15], v[60:63], v[104:107]
    v_mfma_f32_16x16x32_bf16 v[108:111], v[12:15], v[64:67], v[108:111]
    v_mfma_f32_16x16x32_bf16 v[112:115], v[12:15], v[68:71], v[112:115]
    s_branch L_wn1_35
L_wn0_34:
    s_cmp_lg_u64 s[72:73], 0
    s_cbranch_scc1 L_wn1_35
    s_mov_b32 s60, 2
    v_mfma_f32_16x16x32_bf16 v[116:119], v[16:19], v[40:43], 0
    v_mfma_f32_16x16x32_bf16 v[120:123], v[16:19], v[44:47], 0
    v_mfma_f32_16x16x32_bf16 v[124:127], v[16:19], v[48:51], 0
    v_mfma_f32_16x16x32_bf16 v[128:131], v[16:19], v[52:55], 0
    v_mfma_f32_16x16x32_bf16 v[116:119], v[20:23], v[56:59], v[116:119]
    v_mfma_f32_16x16x32_bf16 v[120:123], v[20:23], v[60:63], v[120:123]
    v_mfma_f32_16x16x32_bf16 v[124:127], v[20:23], v[64:67], v[124:127]
    v_mfma_f32_16x16x32_bf16 v[128:131], v[20:23], v[68:71], v[128:131]
L_wn1_35:
    s_add_u32 s61, s61, 1
    s_cmp_gt_u32 s61, 200000
    s_cbranch_scc1 L_exit
    s_waitcnt vmcnt(3)
    v_max3_u32 v80, v8, v9, v10
    v_max_u32 v80, v80, v11
    v_cmp_eq_u32 s[62:63], -1, v80
    s_waitcnt vmcnt(2)
    v_max3_u32 v81, v12, v13, v14
    v_max_u32 v81, v81, v15
    v_cmp_eq_u32 s[64:65], -1, v81
    s_waitcnt vmcnt(1)
    v_max3_u32 v82, v16, v17, v18
    v_max_u32 v82, v82, v19
    v_cmp_eq_u32 s[66:67], -1, v82
    s_waitcnt vmcnt(0)
    v_max3_u32 v83, v20, v21, v22
    v_max_u32 v83, v83, v23
    v_cmp_eq_u32 s[68:69], -1, v83
    s_waitcnt lgkmcnt(0)
    v_cmp_ne_u32 vcc, 0, v6
    s_or_b64 s[70:71], s[62:63], s[64:65]
    s_or_b64 s[72:73], s[66:67], s[68:69]
    s_or_b64 s[76:77], s[70:71], s[72:73]
    s_cbranch_scc0 L_wf_33
    s_cbranch_vccnz L_wp_32
    s_sleep 2
    s_branch L_wp_32
L_wf_33:
    s_cbranch_vccnz L_wns_39
    s_mov_b32 s10, 0
L_fw_40:
    ds_read_b32 v6, v4 offset:32
    ds_read_b128 v[24:27], v38 offset:1792
    ds_read_b128 v[28:31], v38 offset:2048
    s_add_u32 s10, s10, 1
    s_cmp_gt_u32 s10, 800000
    s_cbranch_scc1 L_exit
    s_waitcnt lgkmcnt(0)
    v_cmp_le_u32 vcc, 1, v6
    s_cbranch_vccnz L_fd_41
    s_branch L_fw_40
L_fd_41:
L_wns_39:
    s_cmp_eq_u32 s60, 1
    s_cbranch_scc1 L_wf1_36
    s_cmp_eq_u32 s60, 2
    s_cbranch_scc1 L_wf0_37
    v_mfma_f32_16x16x32_bf16 v[100:103], v[8:11], v[40:43], 0
    v_mfma_f32_16x16x32_bf16 v[104:107], v[8:11], v[44:47], 0
    v_mfma_f32_16x16x32_bf16 v[108:111], v[8:11], v[48:51], 0
    v_mfma_f32_16x16x32_bf16 v[112:115], v[8:11], v[52:55], 0
    v_mfma_f32_16x16x32_bf16 v[100:103], v[12:15], v[56:59], v[100:103]
    v_mfma_f32_16x16x32_bf16 v[104:107], v[12:15], v[60:63], v[104:107]
    v_mfma_f32_16x16x32_bf16 v[108:111], v[12:15], v[64:67], v[108:111]
    v_mfma_f32_16x16x32_bf16 v[112:115], v[12:15], v[68:71], v[112:115]
    s_nop 7
L_wf1_36:
    v_mfma_f32_16x16x32_bf16 v[116:119], v[16:19], v[40:43], 0
    v_mul_f32 v72, v100, v24
    v_mul_f32 v74, v104, v24
    v_mfma_f32_16x16x32_bf16 v[120:123], v[16:19], v[44:47], 0
    v_mul_f32 v76, v108, v24
    v_mul_f32 v78, v112, v24
    v_mfma_f32_16x16x32_bf16 v[124:127], v[16:19], v[48:51], 0
    v_fmac_f32 v72, v101, v25
    v_fmac_f32 v74, v105, v25
    v_mfma_f32_16x16x32_bf16 v[128:131], v[16:19], v[52:55], 0
    v_fmac_f32 v76, v109, v25
    v_fmac_f32 v78, v113, v25
    v_mfma_f32_16x16x32_bf16 v[116:119], v[20:23], v[56:59], v[116:119]
    v_fmac_f32 v72, v102, v26
    v_fmac_f32 v74, v106, v26
    v_mfma_f32_16x16x32_bf16 v[120:123], v[20:23], v[60:63], v[120:123]
    v_fmac_f32 v76, v110, v26
    v_fmac_f32 v78, v114, v26
    v_mfma_f32_16x16x32_bf16 v[124:127], v[20:23], v[64:67], v[124:127]
    v_fmac_f32 v72, v103, v27
    v_fmac_f32 v74, v107, v27
    v_mfma_f32_16x16x32_bf16 v[128:131], v[20:23], v[68:71], v[128:131]
    v_fmac_f32 v76, v111, v27
    v_fmac_f32 v78, v115, v27
    v_mul_f32 v73, v116, v28
    v_mul_f32 v75, v120, v28
    s_nop 0
    v_mul_f32 v77, v124, v28
    s_nop 1
    v_mul_f32 v79, v128, v28
    v_fmac_f32 v73, v117, v29
    v_fmac_f32 v75, v121, v29
    v_fmac_f32 v77, v125, v29
    v_fmac_f32 v79, v129, v29
    v_fmac_f32 v73, v118, v30
    v_fmac_f32 v75, v122, v30
    v_fmac_f32 v77, v126, v30
    v_fmac_f32 v79, v130, v30
    v_fmac_f32 v73, v119, v31
    v_fmac_f32 v75, v123, v31
    v_fmac_f32 v77, v127, v31
    v_fmac_f32 v79, v131, v31
    s_branch L_wfe_38
L_wf0_37:
    v_mfma_f32_16x16x32_bf16 v[100:103], v[8:11], v[40:43], 0
    v_mul_f32 v73, v116, v28
    v_mul_f32 v75, v120, v28
    v_mfma_f32_16x16x32_bf16 v[104:107], v[8:11], v[44:47], 0
    v_mul_f32 v77, v124, v28
    v_mul_f32 v79, v128, v28
    v_mfma_f32_16x16x32_bf16 v[108:111], v[8:11], v[48:51], 0
    v_fmac_f32 v73, v117, v29
    v_fmac_f32 v75, v121, v29
    v_mfma_f32_16x16x32_bf16 v[112:115], v[8:11], v[52:55], 0
    v_fmac_f32 v77, v125, v29
    v_fmac_f32 v79, v129, v29
    v_mfma_f32_16x16x32_bf16 v[100:103], v[12:15], v[56:59], v[100:103]
    v_fmac_f32 v73, v118, v30
    v_fmac_f32 v75, v122, v30
    v_mfma_f32_16x16x32_bf16 v[104:107], v[12:15], v[60:63], v[104:107]
    v_fmac_f32 v77, v126, v30
    v_fmac_f32 v79, v130, v30
    v_mfma_f32_16x16x32_bf16 v[108:111], v[12:15], v[64:67], v[108:111]
    v_fmac_f32 v73, v119, v31
    v_fmac_f32 v75, v123, v31
    v_mfma_f32_16x16x32_bf16 v[112:115], v[12:15], v[68:71], v[112:115]
    v_fmac_f32 v77, v127, v31
    v_fmac_f32 v79, v131, v31
    v_mul_f32 v72, v100, v24
    v_mul_f32 v74, v104, v24
    s_nop 0
    v_mul_f32 v76, v108, v24
    s_nop 1
    v_mul_f32 v78, v112, v24
    v_fmac_f32 v72, v101, v25
    v_fmac_f32 v74, v105, v25
    v_fmac_f32 v76, v109, v25
    v_fmac_f32 v78, v113, v25
    v_fmac_f32 v72, v102, v26
    v_fmac_f32 v74, v106, v26
    v_fmac_f32 v76, v110, v26
    v_fmac_f32 v78, v114, v26
    v_fmac_f32 v72, v103, v27
    v_fmac_f32 v74, v107, v27
    v_fmac_f32 v76, v111, v27
    v_fmac_f32 v78, v115, v27
    s_nop 1
L_wfe_38:
    s_nop 0
    v_permlane32_swap_b32 v72, v73
    v_permlane32_swap_b32 v74, v75
    v_permlane32_swap_b32 v76, v77
    v_permlane32_swap_b32 v78, v79
    v_add_f32 v72, v72, v73
    v_add_f32 v74, v74, v75
    v_add_f32 v76, v76, v77
    v_add_f32 v78, v78, v79
    v_permlane16_swap_b32 v72, v74
    s_nop 0
    v_permlane16_swap_b32 v76, v78
    v_add_f32 v72, v72, v74
    v_add_f32 v76, v76, v78
    ds_write2st64_b32 v37, v72, v76 offset0:16 offset1:17
    s_mov_b64 exec, 1
    ds_add_u32 v4, v5 offset:44
    s_mov_b64 exec, -1
    s_branch L_exit
L_g:
    s_and_b32 s14, s2, 0x7c
    s_cmp_eq_u32 s14, 0x7c
    s_cbranch_scc1 L_exit
    s_lshl_b32 s15, s4, 1
    s_add_u32 s15, s15, s7
    s_cmp_lt_u32 s4, 4
    s_cselect_b32 s14, 4, 3
    s_mul_i32 s15, s15, s14
    s_cselect_b32 s14, 0, 8
    s_add_u32 s15, s15, s14
    s_add_u32 s15, s15, s6
    s_sub_u32 s15, s15, 12
    s_waitcnt lgkmcnt(0)
    s_mul_i32 s9, s100, 0x85EBCA6B
    s_add_u32 s9, s9, s8
    s_mul_i32 s9, s9, 0x9E3779B1
    s_add_u32 s9, s9, 0x7F4A7C15
    s_mov_b32 s56, s16
    s_and_b32 s57, s17, 0xffff
    s_mov_b32 s58, 0x800
    s_mov_b32 s59, 0x20000
    v_lshrrev_b32 v16, 5, v0
    v_bfe_u32 v17, v0, 4, 1
    v_bfe_u32 v18, v0, 3, 1
    v_bfe_u32 v19, v0, 2, 1
    v_and_b32 v20, 3, v0
    v_lshl_add_u32 v21, v17, 1, v19
    v_lshlrev_b32 v2, 7, v21
    v_lshl_add_u32 v2, v20, 5, v2
    v_lshl_add_u32 v2, v18, 4, v2
    v_lshl_add_u32 v2, v16, 3, v2
    v_lshlrev_b32 v3, 5, v21
    v_lshl_add_u32 v3, v20, 3, v3
    v_lshl_add_u32 v3, v16, 2, v3
    v_lshl_add_u32 v3, v18, 10, v3
    s_lshl_b32 s60, s12, 7
    buffer_load_dword v161, v3, s[56:59], s60 offen
    v_lshlrev_b32 v160, 8, v21
    v_lshl_add_u32 v160, v20, 5, v160
    v_lshl_add_u32 v160, v18, 4, v160
    v_lshl_add_u32 v160, v16, 2, v160
    s_lshr_b32 s60, s12, 2
    s_lshl_b32 s60, s60, 10
    s_bfe_u32 s61, s12, 0x10001
    s_lshl_b32 s61, s61, 3
    s_add_u32 s60, s60, s61
    s_and_b32 s61, s12, 1
    s_lshl_b32 s61, s61, 7
    s_add_u32 s60, s60, s61
    v_add_u32 v160, s60, v160
    v_and_b32 v3, 31, v0
    v_lshlrev_b32 v3, 4, v3
    v_lshl_add_u32 v3, v16, 12, v3
    s_lshl_b32 s60, s12, 9
    s_and_b32 s64, s4, 7
    s_lshl_b32 s64, s64, 15
    s_add_u32 s64, s64, s60
    s_add_u32 s64, s64, 0x80000
    s_add_u32 s65, s64, 8192
    s_add_u32 s66, s64, 16384
    s_add_u32 s67, s64, 24576
    s_add_u32 s60, s60, 0x4000
    s_add_u32 s69, s60, 8192
    v_lshlrev_b32 v144, 2, v18
    s_lshl_b32 s61, s12, 9
    v_lshl_add_u32 v145, v0, 3, s61
    v_lshrrev_b32 v146, 2, v0
    v_mul_u32_u24 v146, 1056, v146
    v_lshl_add_u32 v146, v20, 3, v146
    s_lshl_b32 s61, s12, 7
    s_add_u32 s61, s61, 30720
    v_add_u32 v146, s61, v146
    v_and_b32 v147, 1, v0
    v_lshlrev_b32 v147, 6, v147
    v_lshrrev_b32 v148, 4, v0
    v_lshl_add_u32 v147, v148, 3, v147
    v_add_u32 v147, 2304, v147
    v_lshlrev_b32 v148, 13, v148
    v_and_b32 v16, 15, v0
    v_lshl_add_u32 v148, v16, 3, v148
    s_lshl_b32 s68, s12, 15
    s_lshl_b32 s61, s15, 7
    s_add_u32 s68, s68, s61
    s_add_u32 s68, s68, 0xc0000
    v_mov_b32 v149, -2
    s_mov_b32 s79, 0
    s_mov_b32 s10, 0
L_fw_45:
    ds_read_b32 v6, v4 offset:100
    ds_read_b32 v150, v144 offset:2528
    s_add_u32 s10, s10, 1
    s_cmp_gt_u32 s10, 800000
    s_cbranch_scc1 L_exit
    s_waitcnt lgkmcnt(0)
    v_cmp_le_u32 vcc, 1, v6
    s_cbranch_vccnz L_fd_46
    s_sleep 8
    s_branch L_fw_45
L_fd_46:
    s_mov_b32 s10, 0
L_fw_47:
    ds_read_b32 v6, v4 offset:20
    s_add_u32 s10, s10, 1
    s_cmp_gt_u32 s10, 800000
    s_cbranch_scc1 L_exit
    s_waitcnt lgkmcnt(0)
    v_cmp_le_u32 vcc, 1, v6
    s_cbranch_vccnz L_fd_48
    s_sleep 8
    s_branch L_fw_47
L_fd_48:
    s_cmp_ge_u32 s12, 4
    s_cbranch_scc1 L_gv_49
    s_mov_b32 s10, 0
    s_branch L_pgo_51
L_poll_50:
    s_sleep 8
L_pgo_51:
    buffer_load_dwordx2 v[16:17], v2, s[44:47], s60 offen sc1
    buffer_load_dwordx2 v[18:19], v2, s[44:47], s69 offen sc1
L_pck_52:
    s_add_u32 s10, s10, 1
    s_cmp_gt_u32 s10, 200000
    s_cbranch_scc1 L_exit
    s_waitcnt vmcnt(1)
    v_xor_b32 v7, s9, v17
    s_waitcnt vmcnt(0)
    v_bitop3_b32 v7, v7, v19, s9 bitop3:0xF6
    v_cmp_ne_u32 vcc, 0, v7
    s_cbranch_vccnz L_poll_50
    v_lshlrev_b32 v162, 16, v16
    v_and_b32 v163, s74, v16
    v_lshlrev_b32 v164, 16, v161
    v_and_b32 v165, s74, v161
    v_lshlrev_b32 v152, 16, v18
    v_and_b32 v153, s74, v18
    v_pk_add_f32 v[152:153], v[152:153], 1.0 op_sel_hi:[1,0]
    v_cvt_pk_bf16_f32 v18, v152, v153
    v_lshlrev_b32 v152, 16, v18
    v_and_b32 v153, s74, v18
    s_branch L_gg_44
L_gv_49:
    s_sub_u32 s70, s12, 4
    v_bfe_u32 v24, v0, 3, 1
    v_lshrrev_b32 v25, 4, v0
    v_lshl_add_u32 v24, v24, 2, v25
    v_lshlrev_b32 v24, 7, v24
    v_and_b32 v25, 7, v0
    v_lshl_add_u32 v24, v25, 4, v24
    s_mov_b32 s62, 0x5000
    s_mov_b32 s63, 0x6000
    v_lshrrev_b32 v16, 4, v0
    v_lshlrev_b32 v26, 4, v16
    v_bfe_u32 v17, v0, 2, 2
    v_add_u32 v26, v26, v17
    v_lshlrev_b32 v26, 6, v26
    v_bfe_u32 v17, v0, 1, 1
    v_lshl_add_u32 v26, v17, 15, v26
    v_and_b32 v16, 1, v16
    v_lshl_add_u32 v16, v17, 1, v16
    v_xor_b32 v16, s70, v16
    v_lshl_add_u32 v26, v16, 4, v26
    v_and_b32 v16, 1, v0
    v_lshl_add_u32 v26, v16, 3, v26
    v_add_u32 v26, 0x18000, v26
    v_lshrrev_b32 v28, 5, v0
    v_lshlrev_b32 v28, 6, v28
    v_and_b32 v29, 7, v0
    v_lshl_add_u32 v28, v29, 1, v28
    s_lshl_b32 s61, s70, 4
    v_add_u32 v28, s61, v28
    v_lshrrev_b32 v30, 5, v0
    v_lshlrev_b32 v30, 3, v30
    s_mov_b32 s10, 0
L_fw_53:
    ds_read_b32 v6, v4 offset:96
    s_add_u32 s10, s10, 1
    s_cmp_gt_u32 s10, 800000
    s_cbranch_scc1 L_exit
    s_waitcnt lgkmcnt(0)
    v_cmp_le_u32 vcc, 1, v6
    s_cbranch_vccnz L_fd_54
    s_sleep 1
    s_branch L_fw_53
L_fd_54:
    s_mov_b32 s10, 0
    buffer_load_dwordx2 v[16:17], v2, s[44:47], s60 offen sc1
    buffer_load_dwordx2 v[18:19], v2, s[44:47], s69 offen sc1
    buffer_load_dwordx4 v[32:35], v24, s[44:47], s62 offen offset:0 sc1
    buffer_load_dwordx4 v[36:39], v24, s[44:47], s62 offen offset:1024 sc1
    buffer_load_dwordx4 v[40:43], v24, s[44:47], s62 offen offset:2048 sc1
    buffer_load_dwordx4 v[44:47], v24, s[44:47], s62 offen offset:3072 sc1
    buffer_load_dwordx4 v[48:51], v24, s[44:47], s63 offen offset:0 sc1
    buffer_load_dwordx4 v[52:55], v24, s[44:47], s63 offen offset:1024 sc1
    buffer_load_dwordx4 v[56:59], v24, s[44:47], s63 offen offset:2048 sc1
    buffer_load_dwordx4 v[60:63], v24, s[44:47], s63 offen offset:3072 sc1
    s_mov_b64 exec, 1
    ds_add_u32 v4, v5 offset:68
    s_mov_b64 exec, -1
    s_mov_b32 s10, 0
L_fw_57:
    ds_read_b32 v6, v4 offset:36
    s_add_u32 s10, s10, 1
    s_cmp_gt_u32 s10, 800000
    s_cbranch_scc1 L_exit
    s_waitcnt lgkmcnt(0)
    v_cmp_le_u32 vcc, 1, v6
    s_cbranch_vccnz L_fd_58
    s_sleep 1
    s_branch L_fw_57
L_fd_58:
    ds_read_b64_tr_b16 v[64:65], v26 offset:0
    ds_read_b64_tr_b16 v[66:67], v26 offset:8192
    ds_read_b64_tr_b16 v[68:69], v26 offset:256
    ds_read_b64_tr_b16 v[70:71], v26 offset:8448
    ds_read_b64_tr_b16 v[72:73], v26 offset:512
    ds_read_b64_tr_b16 v[74:75], v26 offset:8704
    ds_read_b64_tr_b16 v[76:77], v26 offset:768
    ds_read_b64_tr_b16 v[78:79], v26 offset:8960
    ds_read_b64_tr_b16 v[80:81], v26 offset:4096
    ds_read_b64_tr_b16 v[82:83], v26 offset:12288
    ds_read_b64_tr_b16 v[84:85], v26 offset:4352
    ds_read_b64_tr_b16 v[86:87], v26 offset:12544
    s_waitcnt lgkmcnt(3)
    ds_read_b64_tr_b16 v[88:89], v26 offset:4608
    ds_read_b64_tr_b16 v[90:91], v26 offset:12800
    ds_read_b64_tr_b16 v[92:93], v26 offset:4864
    ds_read_b64_tr_b16 v[94:95], v26 offset:13056
    ds_read_b64_tr_b16 v[96:97], v26 offset:16384
    ds_read_b64_tr_b16 v[98:99], v26 offset:24576
    ds_read_b64_tr_b16 v[100:101], v26 offset:16640
    ds_read_b64_tr_b16 v[102:103], v26 offset:24832
    ds_read_b64_tr_b16 v[104:105], v26 offset:16896
    ds_read_b64_tr_b16 v[106:107], v26 offset:25088
    ds_read_b64_tr_b16 v[108:109], v26 offset:17152
    ds_read_b64_tr_b16 v[110:111], v26 offset:25344
    s_waitcnt lgkmcnt(3)
    ds_read_b64_tr_b16 v[112:113], v26 offset:20480
    ds_read_b64_tr_b16 v[114:115], v26 offset:28672
    ds_read_b64_tr_b16 v[116:117], v26 offset:20736
    ds_read_b64_tr_b16 v[118:119], v26 offset:28928
    ds_read_b64_tr_b16 v[120:121], v26 offset:20992
    ds_read_b64_tr_b16 v[122:123], v26 offset:29184
    ds_read_b64_tr_b16 v[124:125], v26 offset:21248
    ds_read_b64_tr_b16 v[126:127], v26 offset:29440
    s_waitcnt lgkmcnt(0)
    s_mov_b32 s10, 0
    s_branch L_pgo_56
L_poll_55:
    s_sleep 8
    buffer_load_dwordx2 v[16:17], v2, s[44:47], s60 offen sc1
    buffer_load_dwordx2 v[18:19], v2, s[44:47], s69 offen sc1
    buffer_load_dwordx4 v[32:35], v24, s[44:47], s62 offen offset:0 sc1
    buffer_load_dwordx4 v[36:39], v24, s[44:47], s62 offen offset:1024 sc1
    buffer_load_dwordx4 v[40:43], v24, s[44:47], s62 offen offset:2048 sc1
    buffer_load_dwordx4 v[44:47], v24, s[44:47], s62 offen offset:3072 sc1
    buffer_load_dwordx4 v[48:51], v24, s[44:47], s63 offen offset:0 sc1
    buffer_load_dwordx4 v[52:55], v24, s[44:47], s63 offen offset:1024 sc1
    buffer_load_dwordx4 v[56:59], v24, s[44:47], s63 offen offset:2048 sc1
    buffer_load_dwordx4 v[60:63], v24, s[44:47], s63 offen offset:3072 sc1
L_pgo_56:
    s_add_u32 s10, s10, 1
    s_cmp_gt_u32 s10, 200000
    s_cbranch_scc1 L_exit
    s_waitcnt vmcnt(9)
    v_xor_b32 v7, s9, v17
    s_waitcnt vmcnt(8)
    v_bitop3_b32 v7, v7, v19, s9 bitop3:0xF6
    s_waitcnt vmcnt(7)
    v_bitop3_b32 v7, v7, v33, s9 bitop3:0xF6
    v_bitop3_b32 v7, v7, v35, s9 bitop3:0xF6
    s_waitcnt vmcnt(6)
    v_bitop3_b32 v7, v7, v37, s9 bitop3:0xF6
    v_bitop3_b32 v7, v7, v39, s9 bitop3:0xF6
    s_waitcnt vmcnt(5)
    v_bitop3_b32 v7, v7, v41, s9 bitop3:0xF6
    v_bitop3_b32 v7, v7, v43, s9 bitop3:0xF6
    s_waitcnt vmcnt(4)
    v_bitop3_b32 v7, v7, v45, s9 bitop3:0xF6
    v_bitop3_b32 v7, v7, v47, s9 bitop3:0xF6
    s_waitcnt vmcnt(3)
    v_bitop3_b32 v7, v7, v49, s9 bitop3:0xF6
    v_bitop3_b32 v7, v7, v51, s9 bitop3:0xF6
    s_waitcnt vmcnt(2)
    v_bitop3_b32 v7, v7, v53, s9 bitop3:0xF6
    v_bitop3_b32 v7, v7, v55, s9 bitop3:0xF6
    s_waitcnt vmcnt(1)
    v_bitop3_b32 v7, v7, v57, s9 bitop3:0xF6
    v_bitop3_b32 v7, v7, v59, s9 bitop3:0xF6
    s_waitcnt vmcnt(0)
    v_bitop3_b32 v7, v7, v61, s9 bitop3:0xF6
    v_bitop3_b32 v7, v7, v63, s9 bitop3:0xF6
    v_cmp_ne_u32 vcc, 0, v7
    s_cbranch_vccnz L_poll_55
    v_lshlrev_b32 v162, 16, v16
    v_and_b32 v163, s74, v16
    v_lshlrev_b32 v164, 16, v161
    v_and_b32 v165, s74, v161
    v_lshlrev_b32 v152, 16, v18
    v_and_b32 v153, s74, v18
    v_pk_add_f32 v[152:153], v[152:153], 1.0 op_sel_hi:[1,0]
    v_cvt_pk_bf16_f32 v18, v152, v153
    v_lshlrev_b32 v152, 16, v18
    v_and_b32 v153, s74, v18
    v_mov_b32 v8, v32
    v_lshlrev_b32 v16, 16, v48
    v_and_b32 v17, s74, v48
    v_pk_add_f32 v[16:17], v[16:17], 1.0 op_sel_hi:[1,0]
    v_cvt_pk_bf16_f32 v128, v16, v17
    v_mov_b32 v9, v34
    v_lshlrev_b32 v16, 16, v50
    v_and_b32 v17, s74, v50
    v_pk_add_f32 v[16:17], v[16:17], 1.0 op_sel_hi:[1,0]
    v_cvt_pk_bf16_f32 v129, v16, v17
    v_mov_b32 v10, v36
    v_lshlrev_b32 v16, 16, v52
    v_and_b32 v17, s74, v52
    v_pk_add_f32 v[16:17], v[16:17], 1.0 op_sel_hi:[1,0]
    v_cvt_pk_bf16_f32 v130, v16, v17
    v_mov_b32 v11, v38
    v_lshlrev_b32 v16, 16, v54
    v_and_b32 v17, s74, v54
    v_pk_add_f32 v[16:17], v[16:17], 1.0 op_sel_hi:[1,0]
    v_cvt_pk_bf16_f32 v131, v16, v17
    v_mov_b32 v12, v40
    v_lshlrev_b32 v16, 16, v56
    v_and_b32 v17, s74, v56
    v_pk_add_f32 v[16:17], v[16:17], 1.0 op_sel_hi:[1,0]
    v_cvt_pk_bf16_f32 v132, v16, v17
    v_mov_b32 v13, v42
    v_lshlrev_b32 v16, 16, v58
    v_and_b32 v17, s74, v58
    v_pk_add_f32 v[16:17], v[16:17], 1.0 op_sel_hi:[1,0]
    v_cvt_pk_bf16_f32 v133, v16, v17
    v_mov_b32 v14, v44
    v_lshlrev_b32 v16, 16, v60
    v_and_b32 v17, s74, v60
    v_pk_add_f32 v[16:17], v[16:17], 1.0 op_sel_hi:[1,0]
    v_cvt_pk_bf16_f32 v134, v16, v17
    v_mov_b32 v15, v46
    v_lshlrev_b32 v16, 16, v62
    v_and_b32 v17, s74, v62
    v_pk_add_f32 v[16:17], v[16:17], 1.0 op_sel_hi:[1,0]
    v_cvt_pk_bf16_f32 v135, v16, v17
    v_mfma_f32_16x16x32_bf16 v[32:35], v[8:11], v[64:67], 0
    v_mfma_f32_16x16x32_bf16 v[36:39], v[8:11], v[68:71], 0
    v_mfma_f32_16x16x32_bf16 v[40:43], v[8:11], v[72:75], 0
    v_mfma_f32_16x16x32_bf16 v[44:47], v[8:11], v[76:79], 0
    v_mfma_f32_16x16x32_bf16 v[48:51], v[8:11], v[80:83], 0
    v_mfma_f32_16x16x32_bf16 v[52:55], v[8:11], v[84:87], 0
    v_mfma_f32_16x16x32_bf16 v[56:59], v[8:11], v[88:91], 0
    v_mfma_f32_16x16x32_bf16 v[60:63], v[8:11], v[92:95], 0
    v_mfma_f32_16x16x32_bf16 v[32:35], v[12:15], v[96:99], v[32:35]
    v_mfma_f32_16x16x32_bf16 v[36:39], v[12:15], v[100:103], v[36:39]
    v_mfma_f32_16x16x32_bf16 v[40:43], v[12:15], v[104:107], v[40:43]
    v_mfma_f32_16x16x32_bf16 v[44:47], v[12:15], v[108:111], v[44:47]
    v_mfma_f32_16x16x32_bf16 v[48:51], v[12:15], v[112:115], v[48:51]
    v_mfma_f32_16x16x32_bf16 v[52:55], v[12:15], v[116:119], v[52:55]
    v_mfma_f32_16x16x32_bf16 v[56:59], v[12:15], v[120:123], v[56:59]
    v_mfma_f32_16x16x32_bf16 v[60:63], v[12:15], v[124:127], v[60:63]
    s_nop 1
    v_add_f32_dpp v26, v32, v38 quad_perm:[0,1,2,3] row_mask:0x1 bank_mask:0xf
    v_add_f32_dpp v27, v33, v39 quad_perm:[0,1,2,3] row_mask:0x1 bank_mask:0xf
    s_nop 0
    v_add_f32_dpp v26, v40, v46 quad_perm:[0,1,2,3] row_mask:0x2 bank_mask:0xf
    v_add_f32_dpp v27, v41, v47 quad_perm:[0,1,2,3] row_mask:0x2 bank_mask:0xf
    s_nop 0
    v_add_f32_dpp v26, v48, v54 quad_perm:[0,1,2,3] row_mask:0x4 bank_mask:0xf
    v_add_f32_dpp v27, v49, v55 quad_perm:[0,1,2,3] row_mask:0x4 bank_mask:0xf
    s_nop 0
    v_add_f32_dpp v26, v56, v62 quad_perm:[0,1,2,3] row_mask:0x8 bank_mask:0xf
    v_add_f32_dpp v27, v57, v63 quad_perm:[0,1,2,3] row_mask:0x8 bank_mask:0xf
    s_nop 1
    v_permlane32_swap_b32 v26, v27
    v_add_f32 v29, v26, v27
    v_mov_b32 v26, v29
    s_nop 1
    v_permlane16_swap_b32 v29, v26
    v_add_f32 v29, v29, v26
    v_mfma_f32_16x16x32_bf16 v[32:35], v[128:131], v[64:67], 0
    v_mfma_f32_16x16x32_bf16 v[36:39], v[128:131], v[68:71], 0
    v_mfma_f32_16x16x32_bf16 v[40:43], v[128:131], v[72:75], 0
    v_mfma_f32_16x16x32_bf16 v[44:47], v[128:131], v[76:79], 0
    v_mfma_f32_16x16x32_bf16 v[48:51], v[128:131], v[80:83], 0
    v_mfma_f32_16x16x32_bf16 v[52:55], v[128:131], v[84:87], 0
    v_mfma_f32_16x16x32_bf16 v[56:59], v[128:131], v[88:91], 0
    v_mfma_f32_16x16x32_bf16 v[60:63], v[128:131], v[92:95], 0
    v_mfma_f32_16x16x32_bf16 v[32:35], v[132:135], v[96:99], v[32:35]
    v_mfma_f32_16x16x32_bf16 v[36:39], v[132:135], v[100:103], v[36:39]
    v_mfma_f32_16x16x32_bf16 v[40:43], v[132:135], v[104:107], v[40:43]
    v_mfma_f32_16x16x32_bf16 v[44:47], v[132:135], v[108:111], v[44:47]
    v_mfma_f32_16x16x32_bf16 v[48:51], v[132:135], v[112:115], v[48:51]
    v_mfma_f32_16x16x32_bf16 v[52:55], v[132:135], v[116:119], v[52:55]
    v_mfma_f32_16x16x32_bf16 v[56:59], v[132:135], v[120:123], v[56:59]
    v_mfma_f32_16x16x32_bf16 v[60:63], v[132:135], v[124:127], v[60:63]
    s_nop 1
    v_add_f32_dpp v26, v32, v38 quad_perm:[0,1,2,3] row_mask:0x1 bank_mask:0xf
    v_add_f32_dpp v27, v33, v39 quad_perm:[0,1,2,3] row_mask:0x1 bank_mask:0xf
    s_nop 0
    v_add_f32_dpp v26, v40, v46 quad_perm:[0,1,2,3] row_mask:0x2 bank_mask:0xf
    v_add_f32_dpp v27, v41, v47 quad_perm:[0,1,2,3] row_mask:0x2 bank_mask:0xf
    s_nop 0
    v_add_f32_dpp v26, v48, v54 quad_perm:[0,1,2,3] row_mask:0x4 bank_mask:0xf
    v_add_f32_dpp v27, v49, v55 quad_perm:[0,1,2,3] row_mask:0x4 bank_mask:0xf
    s_nop 0
    v_add_f32_dpp v26, v56, v62 quad_perm:[0,1,2,3] row_mask:0x8 bank_mask:0xf
    v_add_f32_dpp v27, v57, v63 quad_perm:[0,1,2,3] row_mask:0x8 bank_mask:0xf
    s_nop 1
    v_permlane32_swap_b32 v26, v27
    v_add_f32 v31, v26, v27
    v_mov_b32 v26, v31
    s_nop 1
    v_permlane16_swap_b32 v31, v26
    v_add_f32 v31, v31, v26
L_gg_44:
    s_mov_b32 s10, 0
L_fw_59:
    ds_read_b32 v6, v4 offset:80
    ds_read_b32 v16, v4 offset:40
    s_add_u32 s10, s10, 1
    s_cmp_gt_u32 s10, 800000
    s_cbranch_scc1 L_exit
    s_waitcnt lgkmcnt(0)
    v_cmp_le_u32 vcc, 1, v6
    s_cbranch_vccnz L_fd_60
    s_sleep 1
    s_branch L_fw_59
L_fd_60:
    v_cmp_ne_u32 vcc, 0, v16
    s_cbranch_vccz L_nwd_61
    s_mov_b32 s79, 1
    ds_read_b64_tr_b16 v[128:129], v146 offset:0
    ds_read_b64_tr_b16 v[130:131], v146 offset:16896
    ds_read_b64_tr_b16 v[132:133], v146 offset:32
    ds_read_b64_tr_b16 v[134:135], v146 offset:16928
    ds_read_b64_tr_b16 v[136:137], v146 offset:64
    ds_read_b64_tr_b16 v[138:139], v146 offset:16960
    ds_read_b64_tr_b16 v[140:141], v146 offset:96
    ds_read_b64_tr_b16 v[142:143], v146 offset:16992
L_nwd_61:
    buffer_load_dwordx4 v[32:35], v3, s[44:47], s64 offen sc1
    buffer_load_dwordx4 v[36:39], v3, s[44:47], s65 offen sc1
    buffer_load_dwordx4 v[40:43], v3, s[44:47], s66 offen sc1
    buffer_load_dwordx4 v[44:47], v3, s[44:47], s67 offen sc1
    s_mov_b32 s10, 0
    s_waitcnt vmcnt(3)
    v_max3_u32 v20, v32, v33, v34
    v_max_u32 v20, v20, v35
    s_waitcnt vmcnt(2)
    v_max3_u32 v21, v36, v37, v38
    v_max_u32 v21, v21, v39
    s_waitcnt vmcnt(1)
    v_max3_u32 v22, v40, v41, v42
    v_max_u32 v22, v22, v43
    s_waitcnt vmcnt(0)
    v_max3_u32 v23, v44, v45, v46
    v_max_u32 v23, v23, v47
L_pm_62:
    v_max3_u32 v7, v20, v21, v22
    v_max_u32 v7, v7, v23
    v_cmp_eq_u32 vcc, -1, v7
    s_cbranch_vccz L_pmd_63
    v_cmp_eq_u32 vcc, -1, v20
    s_cbranch_vccz L_pk_64
    buffer_load_dwordx4 v[32:35], v3, s[44:47], s64 offen sc1
L_pk_64:
    v_cmp_eq_u32 vcc, -1, v21
    s_cbranch_vccz L_pk_65
    buffer_load_dwordx4 v[36:39], v3, s[44:47], s65 offen sc1
L_pk_65:
    v_cmp_eq_u32 vcc, -1, v22
    s_cbranch_vccz L_pk_66
    buffer_load_dwordx4 v[40:43], v3, s[44:47], s66 offen sc1
L_pk_66:
    v_cmp_eq_u32 vcc, -1, v23
    s_cbranch_vccz L_pk_67
    buffer_load_dwordx4 v[44:47], v3, s[44:47], s67 offen sc1
L_pk_67:
    s_add_u32 s10, s10, 1
    s_cmp_gt_u32 s10, 200000
    s_cbranch_scc1 L_exit
    s_waitcnt vmcnt(0)
    v_max3_u32 v20, v32, v33, v34
    v_max_u32 v20, v20, v35
    v_max3_u32 v21, v36, v37, v38
    v_max_u32 v21, v21, v39
    v_max3_u32 v22, v40, v41, v42
    v_max_u32 v22, v22, v43
    v_max3_u32 v23, v44, v45, v46
    v_max_u32 v23, v23, v47
    s_branch L_pm_62
L_pmd_63:
    v_pk_add_f32 v[16:17], v[32:33], v[36:37]
    v_pk_add_f32 v[18:19], v[34:35], v[38:39]
    v_pk_add_f32 v[20:21], v[40:41], v[44:45]
    v_pk_add_f32 v[22:23], v[42:43], v[46:47]
    v_pk_add_f32 v[16:17], v[16:17], v[20:21]
    v_pk_add_f32 v[18:19], v[18:19], v[22:23]
    s_nop 1
    v_permlane32_swap_b32 v16, v18
    v_permlane32_swap_b32 v17, v19
    v_pk_add_f32 v[16:17], v[16:17], v[18:19]
    v_cvt_pk_bf16_f32 v18, v16, v17
    v_lshlrev_b32 v16, 16, v18
    v_and_b32 v17, s74, v18
    v_pk_mul_f32 v[16:17], v[16:17], v[162:163]
    v_cvt_pk_bf16_f32 v18, v16, v17
    v_lshlrev_b32 v16, 16, v18
    v_and_b32 v17, s74, v18
    v_pk_add_f32 v[16:17], v[16:17], v[164:165]
    v_cvt_pk_bf16_f32 v18, v16, v17
    v_lshlrev_b32 v16, 16, v18
    v_and_b32 v17, s74, v18
    v_pk_add_f32 v[16:17], v[16:17], v[150:151] op_sel_hi:[1,0] neg_lo:[0,1] neg_hi:[0,1]
    v_pk_mul_f32 v[20:21], v[16:17], v[152:153]
    v_mul_f32 v23, v16, v16
    v_add_f32 v22, v16, v17
    v_cvt_pk_bf16_f32 v19, v20, v21
    v_fmac_f32 v23, v17, v17
    ds_write2st64_b32 v160, v18, v19 offset0:16 offset1:24
    ds_write_b64 v145, v[22:23] offset:8192
    s_mov_b64 exec, 1
    ds_add_u32 v4, v5 offset:48
    s_mov_b64 exec, -1
    s_cmp_lt_u32 s12, 4
    s_cbranch_scc1 L_g2_42
    s_mov_b32 s10, 0
L_fw_68:
    ds_read_b32 v6, v4 offset:48
    ds_read_b128 v[8:11], v1 offset:6144
    ds_read_b128 v[12:15], v1 offset:7168
    s_add_u32 s10, s10, 1
    s_cmp_gt_u32 s10, 800000
    s_cbranch_scc1 L_exit
    s_waitcnt lgkmcnt(0)
    v_cmp_le_u32 vcc, 8, v6
    s_cbranch_vccnz L_fd_69
    s_branch L_fw_68
L_fd_69:
    v_mfma_f32_16x16x32_bf16 v[32:35], v[8:11], v[64:67], 0
    v_mfma_f32_16x16x32_bf16 v[36:39], v[8:11], v[68:71], 0
    v_mfma_f32_16x16x32_bf16 v[40:43], v[8:11], v[72:75], 0
    v_mfma_f32_16x16x32_bf16 v[44:47], v[8:11], v[76:79], 0
    v_mfma_f32_16x16x32_bf16 v[48:51], v[8:11], v[80:83], 0
    v_mfma_f32_16x16x32_bf16 v[52:55], v[8:11], v[84:87], 0
    v_mfma_f32_16x16x32_bf16 v[56:59], v[8:11], v[88:91], 0
    v_mfma_f32_16x16x32_bf16 v[60:63], v[8:11], v[92:95], 0
    v_mfma_f32_16x16x32_bf16 v[32:35], v[12:15], v[96:99], v[32:35]
    v_mfma_f32_16x16x32_bf16 v[36:39], v[12:15], v[100:103], v[36:39]
    v_mfma_f32_16x16x32_bf16 v[40:43], v[12:15], v[104:107], v[40:43]
    v_mfma_f32_16x16x32_bf16 v[44:47], v[12:15], v[108:111], v[44:47]
    v_mfma_f32_16x16x32_bf16 v[48:51], v[12:15], v[112:115], v[48:51]
    v_mfma_f32_16x16x32_bf16 v[52:55], v[12:15], v[116:119], v[52:55]
    v_mfma_f32_16x16x32_bf16 v[56:59], v[12:15], v[120:123], v[56:59]
    v_mfma_f32_16x16x32_bf16 v[60:63], v[12:15], v[124:127], v[60:63]
    ds_read_b32 v6, v4 offset:84
    ds_read_b64 v[18:19], v30 offset:2496
    v_add_f32_dpp v26, v32, v38 quad_perm:[0,1,2,3] row_mask:0x1 bank_mask:0xf
    v_add_f32_dpp v27, v33, v39 quad_perm:[0,1,2,3] row_mask:0x1 bank_mask:0xf
    s_nop 0
    v_add_f32_dpp v26, v40, v46 quad_perm:[0,1,2,3] row_mask:0x2 bank_mask:0xf
    v_add_f32_dpp v27, v41, v47 quad_perm:[0,1,2,3] row_mask:0x2 bank_mask:0xf
    s_nop 0
    v_add_f32_dpp v26, v48, v54 quad_perm:[0,1,2,3] row_mask:0x4 bank_mask:0xf
    v_add_f32_dpp v27, v49, v55 quad_perm:[0,1,2,3] row_mask:0x4 bank_mask:0xf
    s_nop 0
    v_add_f32_dpp v26, v56, v62 quad_perm:[0,1,2,3] row_mask:0x8 bank_mask:0xf
    v_add_f32_dpp v27, v57, v63 quad_perm:[0,1,2,3] row_mask:0x8 bank_mask:0xf
    s_nop 1
    v_permlane32_swap_b32 v26, v27
    v_add_f32 v24, v26, v27
    v_mov_b32 v26, v24
    s_nop 1
    v_permlane16_swap_b32 v24, v26
    v_add_f32 v24, v24, v26
    s_waitcnt lgkmcnt(0)
    v_cmp_ne_u32 vcc, 0, v6
    s_cbranch_vccnz L_rs_70
    s_mov_b32 s10, 0
L_fw_71:
    ds_read_b32 v6, v4 offset:84
    ds_read_b64 v[18:19], v30 offset:2496
    s_add_u32 s10, s10, 1
    s_cmp_gt_u32 s10, 800000
    s_cbranch_scc1 L_exit
    s_waitcnt lgkmcnt(0)
    v_cmp_le_u32 vcc, 1, v6
    s_cbranch_vccnz L_fd_72
    s_branch L_fw_71
L_fd_72:
L_rs_70:
    v_fma_f32 v24, -v19, v31, v24
    v_fma_f32 v24, v24, v18, v29
    v_cvt_pk_bf16_f32 v24, v24, v24
    v_lshlrev_b32 v24, 16, v24
    v_mul_f32 v26, 0xbfb8aa3b, v24
    v_exp_f32 v26, v26
    v_mov_b32_dpp v27, v24 row_ror:8 row_mask:0xf bank_mask:0xf
    v_add_f32 v26, 1.0, v26
    v_rcp_f32 v26, v26
    s_nop 0
    v_mul_f32 v26, v24, v26
    v_cvt_pk_bf16_f32 v26, v26, v26
    v_lshlrev_b32 v26, 16, v26
    v_mul_f32 v26, v26, v27
    v_cvt_pk_bf16_f32 v26, v26, v26
    s_mov_b32 exec_lo, 0xff
    s_mov_b32 exec_hi, 0xff
    ds_write_b16 v28, v26 offset:2304
    s_mov_b64 exec, 1
    ds_add_u32 v4, v5 offset:52
    s_mov_b64 exec, -1
L_g2_42:
    s_cmp_lg_u32 s79, 0
    s_cbranch_scc1 L_hw_73
    s_mov_b32 s10, 0
L_fw_74:
    ds_read_b32 v6, v4 offset:40
    s_add_u32 s10, s10, 1
    s_cmp_gt_u32 s10, 800000
    s_cbranch_scc1 L_exit
    s_waitcnt lgkmcnt(0)
    v_cmp_le_u32 vcc, 1, v6
    s_cbranch_vccnz L_fd_75
    s_sleep 1
    s_branch L_fw_74
L_fd_75:
    ds_read_b64_tr_b16 v[128:129], v146 offset:0
    ds_read_b64_tr_b16 v[130:131], v146 offset:16896
    ds_read_b64_tr_b16 v[132:133], v146 offset:32
    ds_read_b64_tr_b16 v[134:135], v146 offset:16928
    ds_read_b64_tr_b16 v[136:137], v146 offset:64
    ds_read_b64_tr_b16 v[138:139], v146 offset:16960
    ds_read_b64_tr_b16 v[140:141], v146 offset:96
    ds_read_b64_tr_b16 v[142:143], v146 offset:16992
L_hw_73:
    s_cmp_ge_u32 s12, 4
    s_cbranch_scc1 L_dsk_76
    s_mov_b32 s10, 0
L_fw_77:
    ds_read_b32 v6, v4 offset:84
    s_add_u32 s10, s10, 1
    s_cmp_gt_u32 s10, 800000
    s_cbranch_scc1 L_exit
    s_waitcnt lgkmcnt(0)
    v_cmp_le_u32 vcc, 1, v6
    s_cbranch_vccnz L_fd_78
    s_sleep 1
    s_branch L_fw_77
L_fd_78:
L_dsk_76:
    s_mov_b32 s10, 0
L_fw_79:
    ds_read_b32 v6, v4 offset:52
    ds_read2_b64 v[8:11], v147 offset0:0 offset1:4
    s_add_u32 s10, s10, 1
    s_cmp_gt_u32 s10, 800000
    s_cbranch_scc1 L_exit
    s_waitcnt lgkmcnt(0)
    v_cmp_le_u32 vcc, 4, v6
    s_cbranch_vccnz L_fd_80
    s_branch L_fw_79
L_fd_80:
    v_mfma_f32_16x16x32_bf16 v[32:35], v[8:11], v[128:131], 0
    v_mfma_f32_16x16x32_bf16 v[36:39], v[8:11], v[132:135], 0
    v_mfma_f32_16x16x32_bf16 v[40:43], v[8:11], v[136:139], 0
    v_mfma_f32_16x16x32_bf16 v[44:47], v[8:11], v[140:143], 0
    s_nop 4
    v_min_u32_dpp v16, v32, v149 quad_perm:[0,1,2,3] row_mask:0x1 bank_mask:0xf
    v_min_u32_dpp v17, v33, v149 quad_perm:[0,1,2,3] row_mask:0x1 bank_mask:0xf
    s_nop 0
    v_min_u32_dpp v16, v36, v149 quad_perm:[0,1,2,3] row_mask:0x2 bank_mask:0xf
    v_min_u32_dpp v17, v37, v149 quad_perm:[0,1,2,3] row_mask:0x2 bank_mask:0xf
    s_nop 0
    v_min_u32_dpp v16, v40, v149 quad_perm:[0,1,2,3] row_mask:0x4 bank_mask:0xf
    v_min_u32_dpp v17, v41, v149 quad_perm:[0,1,2,3] row_mask:0x4 bank_mask:0xf
    s_nop 0
    v_min_u32_dpp v16, v44, v149 quad_perm:[0,1,2,3] row_mask:0x8 bank_mask:0xf
    v_min_u32_dpp v17, v45, v149 quad_perm:[0,1,2,3] row_mask:0x8 bank_mask:0xf
    buffer_store_dwordx2 v[16:17], v148, s[44:47], s68 offen sc1
    s_waitcnt vmcnt(0)
    s_mov_b64 exec, 1
    ds_add_u32 v4, v5 offset:56
    s_mov_b64 exec, -1
    s_branch L_exit
L_pn:
    s_setprio 2
    s_cmp_lg_u32 s3, 0
    s_cbranch_scc1 L_pz
    s_setprio 3
    v_mov_b32 v12, -1
    v_mov_b32 v13, -1
    v_mov_b32 v14, -1
    v_mov_b32 v15, -1
    s_lshl_b32 s60, s4, 5
    s_add_u32 s60, s60, s5
    s_lshl_b32 s64, s60, 3
    s_add_u32 s64, s64, 0x1000
    s_waitcnt lgkmcnt(0)
    s_mov_b32 s44, s42
    s_and_b32 s45, s43, 0xffff
    s_cmp_lt_u32 s6, 8
    s_cbranch_scc1 L_nor
    s_lshl_b32 s60, s4, 4
    s_lshl_b32 s61, s7, 3
    s_add_u32 s60, s60, s61
    s_add_u32 s60, s60, s6
    s_sub_u32 s60, s60, 8
    s_lshl_b32 s61, s60, 11
    s_add_u32 s61, s61, 0x20000
    buffer_store_dwordx4 v[12:15], v1, s[44:47], s61 offen sc1
    buffer_store_dwordx4 v[12:15], v1, s[44:47], s61 offen offset:1024 sc1
    s_lshl_b32 s61, s60, 8
    s_add_u32 s61, s61, 0x80000
    v_and_b32 v2, 15, v0
    v_lshlrev_b32 v2, 4, v2
    v_lshrrev_b32 v3, 4, v0
    v_lshl_add_u32 v2, v3, 15, v2
    buffer_store_dwordx4 v[12:15], v2, s[44:47], s61 offen sc1
    s_add_u32 s61, s61, 0x20000
    buffer_store_dwordx4 v[12:15], v2, s[44:47], s61 offen sc1
    s_and_b32 s60, s6, 14
    s_cmp_lg_u32 s60, 12
    s_cbranch_scc1 L_nor
    s_lshl_b32 s60, s4, 2
    s_lshl_b32 s61, s7, 1
    s_add_u32 s60, s60, s61
    s_add_u32 s60, s60, s6
    s_sub_u32 s60, s60, 12
    s_lshl_b32 s60, s60, 13
    s_add_u32 s60, s60, 0xc0000
    s_add_u32 s61, s60, 4096
    buffer_store_dwordx4 v[12:15], v1, s[44:47], s60 offen offset:0 sc1
    buffer_store_dwordx4 v[12:15], v1, s[44:47], s60 offen offset:1024 sc1
    buffer_store_dwordx4 v[12:15], v1, s[44:47], s60 offen offset:2048 sc1
    buffer_store_dwordx4 v[12:15], v1, s[44:47], s60 offen offset:3072 sc1
    buffer_store_dwordx4 v[12:15], v1, s[44:47], s61 offen offset:0 sc1
    buffer_store_dwordx4 v[12:15], v1, s[44:47], s61 offen offset:1024 sc1
    buffer_store_dwordx4 v[12:15], v1, s[44:47], s61 offen offset:2048 sc1
L_nor:
    s_branch L_pbar
L_pz:
    s_lshl_b32 s14, s98, 11
    s_add_u32 s14, s14, 8192
    v_add_u32 v6, s14, v1
    v_mov_b32 v16, 0
    v_mov_b32 v17, 0
    v_mov_b32 v18, 0
    v_mov_b32 v19, 0
    ds_write_b128 v6, v[16:19]
    ds_write_b128 v6, v[16:19] offset:1024
    v_lshlrev_b32 v6, 2, v0
    s_mov_b64 exec, 15
    ds_add_u32 v6, v5
    s_mov_b64 exec, -1
L_pbar:
    s_waitcnt lgkmcnt(0)
    s_load_dword s8, s[42:43], 0
    s_load_dword s100, s[42:43], 0xffe00
    s_mov_b32 s44, s42
    s_and_b32 s45, s43, 0xffff
    s_cmp_eq_u32 s3, 0
    s_cbranch_scc1 L_svc
    s_cmp_lt_u32 s12, 7
    s_cbranch_scc1 L_idl
    s_cmp_lt_u32 s6, 4
    s_cbranch_scc1 L_q
    s_cmp_lt_u32 s12, 8
    s_cbranch_scc1 L_idl
    s_cmp_lt_u32 s12, 9
    s_cbranch_scc1 L_exit
    s_cmp_lt_u32 s6, s99
    s_cbranch_scc1 L_ma
    s_cmp_lt_u32 s12, 10
    s_cbranch_scc1 L_exit
    s_cmp_ge_u32 s6, 12
    s_cbranch_scc1 L_gl
    s_branch L_exit
L_idl:
    s_waitcnt vmcnt(0)
    s_mov_b64 exec, 1
    ds_add_u32 v4, v5 offset:28
    s_mov_b64 exec, -1
    s_cmp_lt_u32 s12, 4
    s_cbranch_scc1 L_cst
    s_and_b32 s14, s6, 12
    s_cmp_lg_u32 s14, 8
    s_cbranch_scc1 L_late
    v_lshrrev_b32 v2, 4, v0
    v_bfe_u32 v6, v0, 2, 2
    v_lshl_add_u32 v3, v2, 4, v6
    v_lshlrev_b32 v3, 7, v3
    v_and_b32 v6, 3, v0
    v_lshl_add_u32 v3, v6, 3, v3
    v_bfe_u32 v6, v0, 3, 2
    v_lshl_add_u32 v3, v6, 5, v3
    s_lshl_b32 s14, s12, 13
    s_add_u32 s14, s14, 0x18000
    v_add_u32 v32, s14, v3
    v_xor_b32 v33, 32, v32
    v_xor_b32 v34, 64, v32
    v_xor_b32 v35, 96, v32
    s_lshr_b32 s14, s12, 1
    s_lshl_b32 s14, s14, 6
    v_lshl_add_u32 v38, v2, 4, s14
    s_lshl_b32 s14, s4, 15
    s_add_u32 s14, s14, 0x20000
    s_lshl_b32 s15, s12, 11
    s_add_u32 s14, s14, s15
    s_add_u32 s15, s14, 16384
    s_lshl_b32 s60, s12, 9
    v_lshl_add_u32 v37, v0, 2, s60
    ds_read_b64_tr_b16 v[40:41], v32 offset:0
    ds_read_b64_tr_b16 v[42:43], v32 offset:512
    ds_read_b64_tr_b16 v[44:45], v33 offset:0
    ds_read_b64_tr_b16 v[46:47], v33 offset:512
    ds_read_b64_tr_b16 v[48:49], v34 offset:0
    ds_read_b64_tr_b16 v[50:51], v34 offset:512
    ds_read_b64_tr_b16 v[52:53], v35 offset:0
    ds_read_b64_tr_b16 v[54:55], v35 offset:512
    ds_read_b64_tr_b16 v[56:57], v32 offset:1024
    ds_read_b64_tr_b16 v[58:59], v32 offset:1536
    s_waitcnt lgkmcnt(3)
    ds_read_b64_tr_b16 v[60:61], v33 offset:1024
    ds_read_b64_tr_b16 v[62:63], v33 offset:1536
    ds_read_b64_tr_b16 v[64:65], v34 offset:1024
    ds_read_b64_tr_b16 v[66:67], v34 offset:1536
    ds_read_b64_tr_b16 v[68:69], v35 offset:1024
    ds_read_b64_tr_b16 v[70:71], v35 offset:1536
    s_branch L_late
L_q:
    s_setprio 3
    s_sub_u32 s15, s12, 7
    s_mov_b32 s56, s16
    s_and_b32 s57, s17, 0xffff
    s_mov_b32 s58, 0x800
    s_mov_b32 s59, 0x20000
    v_and_b32 v28, 1, v0
    v_lshlrev_b32 v28, 10, v28
    v_lshrrev_b32 v29, 1, v0
    v_lshl_add_u32 v30, v29, 5, v28
    buffer_load_dwordx4 v[8:11], v30, s[56:59], 0 offen
    buffer_load_dwordx4 v[12:15], v30, s[56:59], 0 offen offset:16
    v_lshl_add_u32 v30, v29, 2, v28
    s_lshl_b32 s65, s15, 8
    buffer_load_dword v22, v30, s[56:59], s65 offen
    buffer_load_dword v23, v30, s[56:59], s65 offen offset:128
    s_waitcnt lgkmcnt(0)
    s_mul_i32 s9, s100, 0x85EBCA6B
    s_add_u32 s9, s9, s8
    s_mul_i32 s9, s9, 0x9E3779B1
    s_add_u32 s9, s9, 0x7F4A7C15
    v_lshrrev_b32 v16, 4, v0
    v_lshlrev_b32 v2, 4, v16
    v_bfe_u32 v17, v0, 2, 2
    v_add_u32 v2, v2, v17
    v_lshlrev_b32 v2, 7, v2
    v_and_b32 v16, 1, v16
    v_bfe_u32 v17, v0, 3, 1
    v_lshl_add_u32 v16, v16, 1, v17
    v_xor_b32 v16, s15, v16
    v_lshl_add_u32 v2, v16, 5, v2
    v_and_b32 v16, 3, v0
    v_lshl_add_u32 v2, v16, 3, v2
    v_add_u32 v2, 0x18000, v2
    v_and_b32 v28, 15, v0
    v_lshlrev_b32 v28, 2, v28
    v_lshrrev_b32 v29, 5, v0
    v_lshl_add_u32 v28, v29, 11, v28
    s_lshl_b32 s64, s4, 12
    s_lshl_b32 s61, s7, 10
    s_add_u32 s64, s64, s61
    s_lshl_b32 s61, s6, 8
    s_add_u32 s64, s64, s61
    s_lshl_b32 s61, s15, 6
    s_add_u32 s64, s64, s61
    s_add_u32 s64, s64, 0x8000
    s_and_b32 s66, s4, 0
    s_lshl_b32 s66, s66, 15
    s_lshl_b32 s61, s15, 11
    s_add_u32 s66, s66, s61
    s_add_u32 s66, s66, 0x60000
    s_add_u32 s67, s66, 16384
    s_add_u32 s68, s66, 8192
    s_add_u32 s69, s66, 24576
    v_lshrrev_b32 v29, 4, v0
    v_lshlrev_b32 v29, 8, v29
    v_bfe_u32 v30, v0, 2, 2
    v_lshl_add_u32 v29, v30, 5, v29
    v_and_b32 v30, 1, v0
    v_lshl_add_u32 v29, v30, 4, v29
    v_bfe_u32 v30, v0, 1, 1
    v_lshl_add_u32 v29, v30, 2, v29
    s_lshr_b32 s61, s15, 1
    s_lshl_b32 s61, s61, 10
    s_and_b32 s60, s15, 1
    s_lshl_b32 s60, s60, 3
    s_add_u32 s61, s61, s60
    s_add_u32 s61, s61, 4096
    v_add_u32 v29, s61, v29
    v_mov_b32 v31, s9
    s_waitcnt vmcnt(0)
    s_mov_b64 exec, 1
    ds_add_u32 v4, v5 offset:28
    s_mov_b64 exec, -1
    v_lshlrev_b32 v32, 16, v8
    v_and_b32 v33, s74, v8
    v_lshlrev_b32 v34, 16, v9
    v_and_b32 v35, s74, v9
    v_lshlrev_b32 v36, 16, v10
    v_and_b32 v37, s74, v10
    v_lshlrev_b32 v38, 16, v11
    v_and_b32 v39, s74, v11
    v_lshlrev_b32 v40, 16, v12
    v_and_b32 v41, s74, v12
    v_lshlrev_b32 v42, 16, v13
    v_and_b32 v43, s74, v13
    v_lshlrev_b32 v44, 16, v14
    v_and_b32 v45, s74, v14
    v_lshlrev_b32 v46, 16, v15
    v_and_b32 v47, s74, v15
    v_pk_add_f32 v[16:17], v[32:33], v[34:35]
    v_pk_add_f32 v[16:17], v[16:17], v[36:37]
    v_pk_add_f32 v[16:17], v[16:17], v[38:39]
    v_pk_add_f32 v[16:17], v[16:17], v[40:41]
    v_pk_add_f32 v[16:17], v[16:17], v[42:43]
    v_pk_add_f32 v[16:17], v[16:17], v[44:45]
    v_pk_add_f32 v[16:17], v[16:17], v[46:47]
    v_add_f32 v16, v16, v17
    s_nop 1
    v_add_f32_dpp v16, v16, v16 quad_perm:[2,3,0,1] row_mask:0xf bank_mask:0xf
    s_nop 1
    v_add_f32_dpp v16, v16, v16 row_ror:4 row_mask:0xf bank_mask:0xf
    s_nop 1
    v_add_f32_dpp v16, v16, v16 row_ror:8 row_mask:0xf bank_mask:0xf
    v_mov_b32 v17, v16
    s_nop 1
    v_permlane16_swap_b32 v16, v17
    v_add_f32 v16, v16, v17
    v_mov_b32 v17, v16
    s_nop 1
    v_permlane32_swap_b32 v16, v17
    v_add_f32 v16, v16, v17
    v_mul_f32 v16, 0x3b000000, v16
    v_pk_add_f32 v[32:33], v[32:33], v[16:17] op_sel_hi:[1,0] neg_lo:[0,1] neg_hi:[0,1]
    v_pk_add_f32 v[34:35], v[34:35], v[16:17] op_sel_hi:[1,0] neg_lo:[0,1] neg_hi:[0,1]
    v_pk_add_f32 v[36:37], v[36:37], v[16:17] op_sel_hi:[1,0] neg_lo:[0,1] neg_hi:[0,1]
    v_pk_add_f32 v[38:39], v[38:39], v[16:17] op_sel_hi:[1,0] neg_lo:[0,1] neg_hi:[0,1]
    v_pk_add_f32 v[40:41], v[40:41], v[16:17] op_sel_hi:[1,0] neg_lo:[0,1] neg_hi:[0,1]
    v_pk_add_f32 v[42:43], v[42:43], v[16:17] op_sel_hi:[1,0] neg_lo:[0,1] neg_hi:[0,1]
    v_pk_add_f32 v[44:45], v[44:45], v[16:17] op_sel_hi:[1,0] neg_lo:[0,1] neg_hi:[0,1]
    v_pk_add_f32 v[46:47], v[46:47], v[16:17] op_sel_hi:[1,0] neg_lo:[0,1] neg_hi:[0,1]
    v_pk_mul_f32 v[18:19], v[32:33], v[32:33]
    v_pk_fma_f32 v[18:19], v[34:35], v[34:35], v[18:19]
    v_pk_fma_f32 v[18:19], v[36:37], v[36:37], v[18:19]
    v_pk_fma_f32 v[18:19], v[38:39], v[38:39], v[18:19]
    v_pk_fma_f32 v[18:19], v[40:41], v[40:41], v[18:19]
    v_pk_fma_f32 v[18:19], v[42:43], v[42:43], v[18:19]
    v_pk_fma_f32 v[18:19], v[44:45], v[44:45], v[18:19]
    v_pk_fma_f32 v[18:19], v[46:47], v[46:47], v[18:19]
    v_add_f32 v18, v18, v19
    s_nop 1
    v_add_f32_dpp v18, v18, v18 quad_perm:[2,3,0,1] row_mask:0xf bank_mask:0xf
    s_nop 1
    v_add_f32_dpp v18, v18, v18 row_ror:4 row_mask:0xf bank_mask:0xf
    s_nop 1
    v_add_f32_dpp v18, v18, v18 row_ror:8 row_mask:0xf bank_mask:0xf
    v_mov_b32 v19, v18
    s_nop 1
    v_permlane16_swap_b32 v18, v19
    v_add_f32 v18, v18, v19
    v_mov_b32 v19, v18
    s_nop 1
    v_permlane32_swap_b32 v18, v19
    v_add_f32 v18, v18, v19
    v_mul_f32 v18, 0x3b000000, v18
    v_cvt_pk_bf16_f32 v18, v18, v18
    v_lshlrev_b32 v18, 16, v18
    v_add_f32 v18, 0x3727c5ac, v18
    v_cvt_pk_bf16_f32 v18, v18, v18
    v_lshlrev_b32 v18, 16, v18
    v_sqrt_f32 v18, v18
    s_nop 0
    v_cvt_pk_bf16_f32 v18, v18, v18
    v_lshlrev_b32 v18, 16, v18
    v_rcp_f32 v18, v18
    v_cvt_pk_bf16_f32 v16, v16, v16
    v_lshlrev_b32 v16, 16, v16
    v_lshlrev_b32 v128, 16, v22
    v_and_b32 v129, s74, v22
    v_pk_add_f32 v[128:129], v[128:129], v[16:17] op_sel_hi:[1,0] neg_lo:[0,1] neg_hi:[0,1]
    v_cvt_pk_bf16_f32 v20, v128, v129
    v_lshlrev_b32 v128, 16, v20
    v_and_b32 v129, s74, v20
    v_pk_mul_f32 v[128:129], v[128:129], v[18:19] op_sel_hi:[1,0]
    v_cvt_pk_bf16_f32 v20, v128, v129
    v_lshlrev_b32 v128, 16, v20
    v_and_b32 v129, s74, v20
    v_lshlrev_b32 v130, 16, v23
    v_and_b32 v131, s74, v23
    v_pk_add_f32 v[130:131], v[130:131], v[16:17] op_sel_hi:[1,0] neg_lo:[0,1] neg_hi:[0,1]
    v_cvt_pk_bf16_f32 v20, v130, v131
    v_lshlrev_b32 v130, 16, v20
    v_and_b32 v131, s74, v20
    v_pk_mul_f32 v[130:131], v[130:131], v[18:19] op_sel_hi:[1,0]
    v_cvt_pk_bf16_f32 v20, v130, v131
    v_lshlrev_b32 v130, 16, v20
    v_and_b32 v131, s74, v20
    s_cmp_lt_u32 s4, 4
    s_cbranch_scc1 L_hA
    s_mov_b32 s10, 0
L_fw_81:
    ds_read_b32 v6, v4 offset:28
    s_add_u32 s10, s10, 1
    s_cmp_gt_u32 s10, 800000
    s_cbranch_scc1 L_exit
    s_waitcnt lgkmcnt(0)
    v_cmp_le_u32 vcc, 8, v6
    s_cbranch_vccnz L_fd_82
    s_branch L_fw_81
L_fd_82:
    buffer_load_dwordx4 v[32:35], v1, s[44:47], s66 offen offset:0 sc1
    buffer_load_dwordx4 v[36:39], v1, s[44:47], s67 offen offset:0 sc1
    buffer_load_dwordx4 v[40:43], v1, s[44:47], s68 offen offset:0 sc1
    buffer_load_dwordx4 v[44:47], v1, s[44:47], s69 offen offset:0 sc1
    buffer_load_dwordx4 v[48:51], v1, s[44:47], s66 offen offset:1024 sc1
    buffer_load_dwordx4 v[52:55], v1, s[44:47], s67 offen offset:1024 sc1
    buffer_load_dwordx4 v[56:59], v1, s[44:47], s68 offen offset:1024 sc1
    buffer_load_dwordx4 v[60:63], v1, s[44:47], s69 offen offset:1024 sc1
L_hA:
    s_mov_b32 s10, 0
L_fw_83:
    ds_read_b32 v6, v4 offset:28
    s_add_u32 s10, s10, 1
    s_cmp_gt_u32 s10, 800000
    s_cbranch_scc1 L_exit
    s_waitcnt lgkmcnt(0)
    v_cmp_le_u32 vcc, 11, v6
    s_cbranch_vccnz L_fd_84
    s_branch L_fw_83
L_fd_84:
    ds_read_b64_tr_b16 v[64:65], v2 offset:0
    ds_read_b64_tr_b16 v[66:67], v2 offset:16384
    ds_read_b64_tr_b16 v[68:69], v2 offset:512
    ds_read_b64_tr_b16 v[70:71], v2 offset:16896
    ds_read_b64_tr_b16 v[72:73], v2 offset:1024
    ds_read_b64_tr_b16 v[74:75], v2 offset:17408
    ds_read_b64_tr_b16 v[76:77], v2 offset:1536
    ds_read_b64_tr_b16 v[78:79], v2 offset:17920
    ds_read_b64_tr_b16 v[80:81], v2 offset:8192
    ds_read_b64_tr_b16 v[82:83], v2 offset:24576
    ds_read_b64_tr_b16 v[84:85], v2 offset:8704
    ds_read_b64_tr_b16 v[86:87], v2 offset:25088
    s_waitcnt lgkmcnt(3)
    ds_read_b64_tr_b16 v[88:89], v2 offset:9216
    ds_read_b64_tr_b16 v[90:91], v2 offset:25600
    ds_read_b64_tr_b16 v[92:93], v2 offset:9728
    ds_read_b64_tr_b16 v[94:95], v2 offset:26112
    ds_read_b64_tr_b16 v[96:97], v2 offset:32768
    ds_read_b64_tr_b16 v[98:99], v2 offset:49152
    ds_read_b64_tr_b16 v[100:101], v2 offset:33280
    ds_read_b64_tr_b16 v[102:103], v2 offset:49664
    ds_read_b64_tr_b16 v[104:105], v2 offset:33792
    ds_read_b64_tr_b16 v[106:107], v2 offset:50176
    ds_read_b64_tr_b16 v[108:109], v2 offset:34304
    ds_read_b64_tr_b16 v[110:111], v2 offset:50688
    s_waitcnt lgkmcnt(3)
    ds_read_b64_tr_b16 v[112:113], v2 offset:40960
    ds_read_b64_tr_b16 v[114:115], v2 offset:57344
    ds_read_b64_tr_b16 v[116:117], v2 offset:41472
    ds_read_b64_tr_b16 v[118:119], v2 offset:57856
    ds_read_b64_tr_b16 v[120:121], v2 offset:41984
    ds_read_b64_tr_b16 v[122:123], v2 offset:58368
    ds_read_b64_tr_b16 v[124:125], v2 offset:42496
    ds_read_b64_tr_b16 v[126:127], v2 offset:58880
    s_waitcnt lgkmcnt(0)
    s_mov_b32 s10, 0
    s_cmp_ge_u32 s4, 4
    s_cbranch_scc1 L_pck_87
    s_sleep 10
    s_branch L_pgo_86
L_poll_85:
    s_sleep 2
L_pgo_86:
    buffer_load_dwordx4 v[32:35], v1, s[44:47], s66 offen offset:0 sc1
    buffer_load_dwordx4 v[36:39], v1, s[44:47], s67 offen offset:0 sc1
    buffer_load_dwordx4 v[40:43], v1, s[44:47], s68 offen offset:0 sc1
    buffer_load_dwordx4 v[44:47], v1, s[44:47], s69 offen offset:0 sc1
    buffer_load_dwordx4 v[48:51], v1, s[44:47], s66 offen offset:1024 sc1
    buffer_load_dwordx4 v[52:55], v1, s[44:47], s67 offen offset:1024 sc1
    buffer_load_dwordx4 v[56:59], v1, s[44:47], s68 offen offset:1024 sc1
    buffer_load_dwordx4 v[60:63], v1, s[44:47], s69 offen offset:1024 sc1
L_pck_87:
    s_add_u32 s10, s10, 1
    s_cmp_gt_u32 s10, 200000
    s_cbranch_scc1 L_exit
    s_waitcnt vmcnt(7)
    v_xor_b32 v7, s9, v33
    v_bitop3_b32 v7, v7, v35, s9 bitop3:0xF6
    s_waitcnt vmcnt(6)
    v_bitop3_b32 v7, v7, v37, s9 bitop3:0xF6
    v_bitop3_b32 v7, v7, v39, s9 bitop3:0xF6
    s_waitcnt vmcnt(5)
    v_bitop3_b32 v7, v7, v41, s9 bitop3:0xF6
    v_bitop3_b32 v7, v7, v43, s9 bitop3:0xF6
    s_waitcnt vmcnt(4)
    v_bitop3_b32 v7, v7, v45, s9 bitop3:0xF6
    v_bitop3_b32 v7, v7, v47, s9 bitop3:0xF6
    s_waitcnt vmcnt(3)
    v_bitop3_b32 v7, v7, v49, s9 bitop3:0xF6
    v_bitop3_b32 v7, v7, v51, s9 bitop3:0xF6
    s_waitcnt vmcnt(2)
    v_bitop3_b32 v7, v7, v53, s9 bitop3:0xF6
    v_bitop3_b32 v7, v7, v55, s9 bitop3:0xF6
    s_waitcnt vmcnt(1)
    v_bitop3_b32 v7, v7, v57, s9 bitop3:0xF6
    v_bitop3_b32 v7, v7, v59, s9 bitop3:0xF6
    s_waitcnt vmcnt(0)
    v_bitop3_b32 v7, v7, v61, s9 bitop3:0xF6
    v_bitop3_b32 v7, v7, v63, s9 bitop3:0xF6
    v_cmp_ne_u32 vcc, 0, v7
    s_cbranch_vccnz L_poll_85
    v_add_f32 v18, v40, v44
    v_add_f32 v19, v42, v46
    v_add_f32 v16, v32, v36
    v_add_f32 v17, v34, v38
    v_add_f32 v22, v56, v60
    v_add_f32 v23, v58, v62
    v_add_f32 v20, v48, v52
    v_add_f32 v21, v50, v54
    v_cvt_pk_bf16_f32 v24, v18, v19
    v_lshlrev_b32 v18, 16, v24
    v_and_b32 v19, s74, v24
    v_cvt_pk_bf16_f32 v25, v22, v23
    v_lshlrev_b32 v22, 16, v25
    v_and_b32 v23, s74, v25
    v_pk_add_f32 v[18:19], v[18:19], 1.0 op_sel_hi:[1,0]
    v_pk_add_f32 v[22:23], v[22:23], 1.0 op_sel_hi:[1,0]
    v_cvt_pk_bf16_f32 v24, v18, v19
    v_lshlrev_b32 v18, 16, v24
    v_and_b32 v19, s74, v24
    v_cvt_pk_bf16_f32 v25, v22, v23
    v_lshlrev_b32 v22, 16, v25
    v_and_b32 v23, s74, v25
    v_pk_mul_f32 v[18:19], v[18:19], v[128:129]
    v_pk_mul_f32 v[22:23], v[22:23], v[130:131]
    v_cvt_pk_bf16_f32 v26, v16, v17
    v_lshlrev_b32 v16, 16, v26
    v_and_b32 v17, s74, v26
    v_cvt_pk_bf16_f32 v27, v20, v21
    v_lshlrev_b32 v20, 16, v27
    v_and_b32 v21, s74, v27
    v_cvt_pk_bf16_f32 v24, v18, v19
    v_lshlrev_b32 v18, 16, v24
    v_and_b32 v19, s74, v24
    v_cvt_pk_bf16_f32 v25, v22, v23
    v_lshlrev_b32 v22, 16, v25
    v_and_b32 v23, s74, v25
    v_pk_add_f32 v[16:17], v[16:17], v[18:19]
    v_pk_add_f32 v[20:21], v[20:21], v[22:23]
    v_cvt_pk_bf16_f32 v24, v16, v17
    v_cvt_pk_bf16_f32 v25, v20, v21
    ds_write2_b32 v29, v24, v25 offset0:0 offset1:32
    s_mov_b64 exec, 1
    ds_add_u32 v4, v5 offset:64
    s_mov_b64 exec, -1
    s_mov_b32 s10, 0
L_fw_88:
    ds_read_b32 v6, v4 offset:64
    ds_read_b128 v[8:11], v1 offset:4096
    ds_read_b128 v[12:15], v1 offset:5120
    s_add_u32 s10, s10, 1
    s_cmp_gt_u32 s10, 800000
    s_cbranch_scc1 L_exit
    s_waitcnt lgkmcnt(0)
    v_cmp_le_u32 vcc, 4, v6
    s_cbranch_vccnz L_fd_89
    s_branch L_fw_88
L_fd_89:
    v_mfma_f32_16x16x32_bf16 v[32:35], v[8:11], v[64:67], 0
    v_mfma_f32_16x16x32_bf16 v[36:39], v[8:11], v[68:71], 0
    v_mfma_f32_16x16x32_bf16 v[40:43], v[8:11], v[72:75], 0
    v_mfma_f32_16x16x32_bf16 v[44:47], v[8:11], v[76:79], 0
    v_mfma_f32_16x16x32_bf16 v[48:51], v[8:11], v[80:83], 0
    v_mfma_f32_16x16x32_bf16 v[52:55], v[8:11], v[84:87], 0
    v_mfma_f32_16x16x32_bf16 v[56:59], v[8:11], v[88:91], 0
    v_mfma_f32_16x16x32_bf16 v[60:63], v[8:11], v[92:95], 0
    v_mfma_f32_16x16x32_bf16 v[32:35], v[12:15], v[96:99], v[32:35]
    v_mfma_f32_16x16x32_bf16 v[36:39], v[12:15], v[100:103], v[36:39]
    v_mfma_f32_16x16x32_bf16 v[40:43], v[12:15], v[104:107], v[40:43]
    v_mfma_f32_16x16x32_bf16 v[44:47], v[12:15], v[108:111], v[44:47]
    v_mfma_f32_16x16x32_bf16 v[48:51], v[12:15], v[112:115], v[48:51]
    v_mfma_f32_16x16x32_bf16 v[52:55], v[12:15], v[116:119], v[52:55]
    v_mfma_f32_16x16x32_bf16 v[56:59], v[12:15], v[120:123], v[56:59]
    v_mfma_f32_16x16x32_bf16 v[60:63], v[12:15], v[124:127], v[60:63]
    s_nop 1
    v_add_f32_dpp v26, v32, v38 quad_perm:[0,1,2,3] row_mask:0x1 bank_mask:0xf
    v_add_f32_dpp v27, v33, v39 quad_perm:[0,1,2,3] row_mask:0x1 bank_mask:0xf
    s_nop 0
    v_add_f32_dpp v26, v40, v46 quad_perm:[0,1,2,3] row_mask:0x2 bank_mask:0xf
    v_add_f32_dpp v27, v41, v47 quad_perm:[0,1,2,3] row_mask:0x2 bank_mask:0xf
    s_nop 0
    v_add_f32_dpp v26, v48, v54 quad_perm:[0,1,2,3] row_mask:0x4 bank_mask:0xf
    v_add_f32_dpp v27, v49, v55 quad_perm:[0,1,2,3] row_mask:0x4 bank_mask:0xf
    s_nop 0
    v_add_f32_dpp v26, v56, v62 quad_perm:[0,1,2,3] row_mask:0x8 bank_mask:0xf
    v_add_f32_dpp v27, v57, v63 quad_perm:[0,1,2,3] row_mask:0x8 bank_mask:0xf
    s_nop 1
    v_permlane32_swap_b32 v26, v27
    v_add_f32 v24, v26, v27
    v_mov_b32 v26, v24
    s_nop 1
    v_permlane16_swap_b32 v24, v26
    v_add_f32 v24, v24, v26
    s_nop 1
    v_mov_b32_dpp v26, v24 quad_perm:[1,0,3,2] row_mask:0xf bank_mask:0xf
    v_cvt_pk_bf16_f32 v30, v24, v26
    s_mov_b32 exec_lo, 0x5555
    s_mov_b32 exec_hi, 0x5555
    buffer_store_dwordx2 v[30:31], v28, s[44:47], s64 offen
    s_add_u32 s64, s64, 0x10000
    buffer_store_dwordx2 v[30:31], v28, s[44:47], s64 offen sc1
    s_mov_b64 exec, -1
    s_mov_b64 exec, 1
    ds_add_u32 v4, v5 offset:72
    s_mov_b64 exec, -1
    s_branch L_exit
L_ma:
    s_setprio 3
    s_mov_b32 s52, s34
    s_and_b32 s53, s35, 0xffff
    s_mov_b32 s54, 0x800
    s_mov_b32 s55, 0x20000
    s_sub_u32 s15, s12, 9
    s_lshl_b32 s63, s4, 3
    s_lshl_b32 s61, s7, 2
    s_add_u32 s63, s63, s61
    s_add_u32 s63, s63, s6
    s_sub_u32 s63, s63, 4
    s_lshr_b32 s65, s63, 4
    v_and_b32 v28, 1, v0
    v_lshlrev_b32 v28, 10, v28
    v_bfe_u32 v29, v0, 3, 1
    v_lshl_add_u32 v28, v29, 7, v28
    v_lshrrev_b32 v29, 4, v0
    v_lshl_add_u32 v28, v29, 5, v28
    v_bfe_u32 v29, v0, 1, 2
    v_lshl_add_u32 v28, v29, 3, v28
    s_lshl_b32 s65, s65, 9
    buffer_load_dwordx2 v[8:9], v28, s[52:55], s65 offen
    buffer_load_dwordx2 v[10:11], v28, s[52:55], s65 offen offset:256
    s_waitcnt lgkmcnt(0)
    s_mul_i32 s9, s100, 0x85EBCA6B
    s_add_u32 s9, s9, s8
    s_mul_i32 s9, s9, 0x9E3779B1
    s_add_u32 s9, s9, 0x7F4A7C15
    v_lshrrev_b32 v16, 4, v0
    v_lshlrev_b32 v2, 4, v16
    v_bfe_u32 v17, v0, 2, 2
    v_add_u32 v2, v2, v17
    v_lshlrev_b32 v2, 7, v2
    v_and_b32 v16, 1, v16
    v_bfe_u32 v17, v0, 3, 1
    v_lshl_add_u32 v16, v16, 1, v17
    v_xor_b32 v16, s15, v16
    v_lshl_add_u32 v2, v16, 5, v2
    v_and_b32 v16, 3, v0
    v_lshl_add_u32 v2, v16, 3, v2
    v_add_u32 v2, 0x18000, v2
    v_xor_b32 v3, 64, v2
    v_bfe_u32 v28, v0, 1, 3
    v_lshlrev_b32 v28, 5, v28
    v_lshrrev_b32 v29, 5, v0
    v_lshl_add_u32 v28, v29, 4, v28
    v_bfe_u32 v29, v0, 4, 1
    v_lshl_add_u32 v28, v29, 15, v28
    s_lshl_b32 s64, s63, 10
    s_lshl_b32 s61, s15, 8
    s_add_u32 s64, s64, s61
    s_add_u32 s64, s64, 0x60000
    v_mov_b32 v17, s9
    v_mov_b32 v19, s9
    v_mov_b32 v21, s9
    v_mov_b32 v23, s9
    s_waitcnt vmcnt(0)
    v_lshlrev_b32 v32, 16, v8
    v_and_b32 v33, s74, v8
    v_lshlrev_b32 v34, 16, v9
    v_and_b32 v35, s74, v9
    v_lshlrev_b32 v36, 16, v10
    v_and_b32 v37, s74, v10
    v_lshlrev_b32 v38, 16, v11
    v_and_b32 v39, s74, v11
    v_mul_f32 v48, 0xbfb8aa3b, v32
    v_mul_f32 v49, 0xbfb8aa3b, v33
    v_mul_f32 v50, 0xbfb8aa3b, v34
    v_mul_f32 v51, 0xbfb8aa3b, v35
    v_mul_f32 v52, 0xbfb8aa3b, v36
    v_mul_f32 v53, 0xbfb8aa3b, v37
    v_mul_f32 v54, 0xbfb8aa3b, v38
    v_mul_f32 v55, 0xbfb8aa3b, v39
    v_exp_f32 v48, v48
    v_exp_f32 v49, v49
    v_exp_f32 v50, v50
    v_exp_f32 v51, v51
    v_exp_f32 v52, v52
    v_exp_f32 v53, v53
    v_exp_f32 v54, v54
    v_exp_f32 v55, v55
    v_add_f32 v48, 1.0, v48
    v_add_f32 v49, 1.0, v49
    v_add_f32 v50, 1.0, v50
    v_add_f32 v51, 1.0, v51
    v_add_f32 v52, 1.0, v52
    v_add_f32 v53, 1.0, v53
    v_add_f32 v54, 1.0, v54
    v_add_f32 v55, 1.0, v55
    v_rcp_f32 v48, v48
    v_rcp_f32 v49, v49
    v_rcp_f32 v50, v50
    v_rcp_f32 v51, v51
    v_rcp_f32 v52, v52
    v_rcp_f32 v53, v53
    v_rcp_f32 v54, v54
    v_rcp_f32 v55, v55
    v_mul_f32 v32, v32, v48
    v_mul_f32 v33, v33, v49
    v_mul_f32 v34, v34, v50
    v_mul_f32 v35, v35, v51
    v_mul_f32 v36, v36, v52
    v_mul_f32 v37, v37, v53
    v_mul_f32 v38, v38, v54
    v_mul_f32 v39, v39, v55
    v_cvt_pk_bf16_f32 v8, v32, v33
    v_cvt_pk_bf16_f32 v9, v34, v35
    v_cvt_pk_bf16_f32 v10, v36, v37
    v_cvt_pk_bf16_f32 v11, v38, v39
    s_mov_b32 s10, 0
L_fw_90:
    ds_read_b32 v6, v4 offset:28
    s_add_u32 s10, s10, 1
    s_cmp_gt_u32 s10, 800000
    s_cbranch_scc1 L_exit
    s_waitcnt lgkmcnt(0)
    v_cmp_le_u32 vcc, 8, v6
    s_cbranch_vccnz L_fd_91
    s_branch L_fw_90
L_fd_91:
    ds_read_b64_tr_b16 v[64:65], v2 offset:0
    ds_read_b64_tr_b16 v[66:67], v2 offset:16384
    ds_read_b64_tr_b16 v[68:69], v2 offset:512
    ds_read_b64_tr_b16 v[70:71], v2 offset:16896
    ds_read_b64_tr_b16 v[72:73], v2 offset:1024
    ds_read_b64_tr_b16 v[74:75], v2 offset:17408
    ds_read_b64_tr_b16 v[76:77], v2 offset:1536
    ds_read_b64_tr_b16 v[78:79], v2 offset:17920
    ds_read_b64_tr_b16 v[80:81], v2 offset:8192
    ds_read_b64_tr_b16 v[82:83], v2 offset:24576
    ds_read_b64_tr_b16 v[84:85], v2 offset:8704
    ds_read_b64_tr_b16 v[86:87], v2 offset:25088
    s_waitcnt lgkmcnt(3)
    ds_read_b64_tr_b16 v[88:89], v2 offset:9216
    ds_read_b64_tr_b16 v[90:91], v2 offset:25600
    ds_read_b64_tr_b16 v[92:93], v2 offset:9728
    ds_read_b64_tr_b16 v[94:95], v2 offset:26112
    ds_read_b64_tr_b16 v[96:97], v3 offset:0
    ds_read_b64_tr_b16 v[98:99], v3 offset:16384
    ds_read_b64_tr_b16 v[100:101], v3 offset:512
    ds_read_b64_tr_b16 v[102:103], v3 offset:16896
    ds_read_b64_tr_b16 v[104:105], v3 offset:1024
    ds_read_b64_tr_b16 v[106:107], v3 offset:17408
    ds_read_b64_tr_b16 v[108:109], v3 offset:1536
    ds_read_b64_tr_b16 v[110:111], v3 offset:17920
    s_waitcnt lgkmcnt(3)
    ds_read_b64_tr_b16 v[112:113], v3 offset:8192
    ds_read_b64_tr_b16 v[114:115], v3 offset:24576
    ds_read_b64_tr_b16 v[116:117], v3 offset:8704
    ds_read_b64_tr_b16 v[118:119], v3 offset:25088
    ds_read_b64_tr_b16 v[120:121], v3 offset:9216
    ds_read_b64_tr_b16 v[122:123], v3 offset:25600
    ds_read_b64_tr_b16 v[124:125], v3 offset:9728
    ds_read_b64_tr_b16 v[126:127], v3 offset:26112
    s_waitcnt lgkmcnt(0)
    v_mfma_f32_16x16x32_bf16 v[32:35], v[8:11], v[64:67], 0
    v_mfma_f32_16x16x32_bf16 v[36:39], v[8:11], v[68:71], 0
    v_mfma_f32_16x16x32_bf16 v[40:43], v[8:11], v[72:75], 0
    v_mfma_f32_16x16x32_bf16 v[44:47], v[8:11], v[76:79], 0
    v_mfma_f32_16x16x32_bf16 v[48:51], v[8:11], v[80:83], 0
    v_mfma_f32_16x16x32_bf16 v[52:55], v[8:11], v[84:87], 0
    v_mfma_f32_16x16x32_bf16 v[56:59], v[8:11], v[88:91], 0
    v_mfma_f32_16x16x32_bf16 v[60:63], v[8:11], v[92:95], 0
    v_mfma_f32_16x16x32_bf16 v[128:131], v[8:11], v[96:99], 0
    v_mfma_f32_16x16x32_bf16 v[132:135], v[8:11], v[100:103], 0
    v_mfma_f32_16x16x32_bf16 v[136:139], v[8:11], v[104:107], 0
    v_mfma_f32_16x16x32_bf16 v[140:143], v[8:11], v[108:111], 0
    v_mfma_f32_16x16x32_bf16 v[144:147], v[8:11], v[112:115], 0
    v_mfma_f32_16x16x32_bf16 v[148:151], v[8:11], v[116:119], 0
    v_mfma_f32_16x16x32_bf16 v[152:155], v[8:11], v[120:123], 0
    v_mfma_f32_16x16x32_bf16 v[156:159], v[8:11], v[124:127], 0
    v_add_f32_dpp v26, v32, v38 quad_perm:[0,1,2,3] row_mask:0x1 bank_mask:0xf
    v_add_f32_dpp v27, v33, v39 quad_perm:[0,1,2,3] row_mask:0x1 bank_mask:0xf
    s_nop 0
    v_add_f32_dpp v26, v40, v46 quad_perm:[0,1,2,3] row_mask:0x2 bank_mask:0xf
    v_add_f32_dpp v27, v41, v47 quad_perm:[0,1,2,3] row_mask:0x2 bank_mask:0xf
    s_nop 0
    v_add_f32_dpp v26, v48, v54 quad_perm:[0,1,2,3] row_mask:0x4 bank_mask:0xf
    v_add_f32_dpp v27, v49, v55 quad_perm:[0,1,2,3] row_mask:0x4 bank_mask:0xf
    s_nop 0
    v_add_f32_dpp v26, v56, v62 quad_perm:[0,1,2,3] row_mask:0x8 bank_mask:0xf
    v_add_f32_dpp v27, v57, v63 quad_perm:[0,1,2,3] row_mask:0x8 bank_mask:0xf
    s_nop 1
    v_permlane32_swap_b32 v26, v27
    v_add_f32 v16, v26, v27
    v_mov_b32 v26, v16
    s_nop 1
    v_permlane16_swap_b32 v16, v26
    v_add_f32 v16, v16, v26
    s_nop 1
    v_mov_b32_dpp v18, v16 quad_perm:[1,0,3,2] row_mask:0xf bank_mask:0xf
    s_mov_b32 exec_lo, 0x5555
    s_mov_b32 exec_hi, 0x5555
    s_add_u32 s61, s64, 0
    buffer_store_dwordx4 v[16:19], v28, s[44:47], s61 offen offset:0 sc1
    s_mov_b64 exec, -1
    v_add_f32_dpp v26, v128, v134 quad_perm:[0,1,2,3] row_mask:0x1 bank_mask:0xf
    v_add_f32_dpp v27, v129, v135 quad_perm:[0,1,2,3] row_mask:0x1 bank_mask:0xf
    s_nop 0
    v_add_f32_dpp v26, v136, v142 quad_perm:[0,1,2,3] row_mask:0x2 bank_mask:0xf
    v_add_f32_dpp v27, v137, v143 quad_perm:[0,1,2,3] row_mask:0x2 bank_mask:0xf
    s_nop 0
    v_add_f32_dpp v26, v144, v150 quad_perm:[0,1,2,3] row_mask:0x4 bank_mask:0xf
    v_add_f32_dpp v27, v145, v151 quad_perm:[0,1,2,3] row_mask:0x4 bank_mask:0xf
    s_nop 0
    v_add_f32_dpp v26, v152, v158 quad_perm:[0,1,2,3] row_mask:0x8 bank_mask:0xf
    v_add_f32_dpp v27, v153, v159 quad_perm:[0,1,2,3] row_mask:0x8 bank_mask:0xf
    s_nop 1
    v_permlane32_swap_b32 v26, v27
    v_add_f32 v20, v26, v27
    v_mov_b32 v26, v20
    s_nop 1
    v_permlane16_swap_b32 v20, v26
    v_add_f32 v20, v20, v26
    s_nop 1
    v_mov_b32_dpp v22, v20 quad_perm:[1,0,3,2] row_mask:0xf bank_mask:0xf
    s_mov_b32 exec_lo, 0x5555
    s_mov_b32 exec_hi, 0x5555
    s_add_u32 s61, s64, 0
    buffer_store_dwordx4 v[20:23], v28, s[44:47], s61 offen offset:512 sc1
    s_mov_b64 exec, -1
    s_mov_b64 exec, 1
    ds_add_u32 v4, v5 offset:88
    s_mov_b64 exec, -1
    s_mov_b32 s48, s36
    s_and_b32 s49, s37, 0xffff
    s_mov_b32 s50, 0x300000
    s_mov_b32 s51, 0x20000
    v_lshrrev_b32 v2, 3, v0
    v_mul_u32_u24 v2, 6144, v2
    v_and_b32 v3, 7, v0
    v_bfe_u32 v6, v0, 4, 1
    v_lshlrev_b32 v6, 1, v6
    v_xor_b32 v3, v3, v6
    v_lshl_add_u32 v2, v3, 4, v2
    v_xor_b32 v3, 64, v2
    s_xor_b32 s63, s63, 4
    s_lshl_b32 s60, s63, 7
    s_add_u32 s60, s60, 2048
    s_mul_i32 s61, s15, 1572864
    s_add_u32 s60, s60, s61
    s_lshl_b32 s61, s15, 15
    s_add_u32 s61, s61, 0x18000
    v_and_b32 v28, 1, v0
    v_lshlrev_b32 v28, 10, v28
    v_bfe_u32 v29, v0, 3, 1
    v_lshl_add_u32 v28, v29, 7, v28
    v_lshrrev_b32 v29, 4, v0
    v_lshl_add_u32 v28, v29, 5, v28
    v_bfe_u32 v29, v0, 1, 2
    v_lshl_add_u32 v28, v29, 3, v28
    buffer_load_dwordx2 v[8:9], v28, s[52:55], 0 offen
    buffer_load_dwordx2 v[10:11], v28, s[52:55], 0 offen offset:256
    buffer_load_dwordx2 v[12:13], v28, s[52:55], 0 offen offset:512
    buffer_load_dwordx2 v[14:15], v28, s[52:55], 0 offen offset:768
    s_mov_b32 s10, 0
L_fw_92:
    ds_read_b32 v6, v4 offset:88
    s_add_u32 s10, s10, 1
    s_cmp_gt_u32 s10, 800000
    s_cbranch_scc1 L_exit
    s_waitcnt lgkmcnt(0)
    v_cmp_le_u32 vcc, 2, v6
    s_cbranch_vccnz L_fd_93
    s_branch L_fw_92
L_fd_93:
    s_mov_b32 s62, 6
L_dma_94:
    s_mov_b32 m0, s61
    s_add_u32 s61, s61, 1024
    buffer_load_dwordx4 v2, s[48:51], s60 offen nt lds
    s_add_u32 s60, s60, 49152
    s_mov_b32 m0, s61
    s_add_u32 s61, s61, 1024
    buffer_load_dwordx4 v2, s[48:51], s60 offen nt lds
    s_add_u32 s60, s60, 49152
    s_mov_b32 m0, s61
    s_add_u32 s61, s61, 1024
    buffer_load_dwordx4 v3, s[48:51], s60 offen nt lds
    s_add_u32 s60, s60, 49152
    s_mov_b32 m0, s61
    s_add_u32 s61, s61, 1024
    buffer_load_dwordx4 v3, s[48:51], s60 offen nt lds
    s_add_u32 s60, s60, 49152
    s_sub_u32 s62, s62, 1
    s_cmp_lg_u32 s62, 0
    s_cbranch_scc1 L_dma_94
    v_mov_b32 v6, 2
    s_mov_b64 exec, 1
    ds_add_u32 v4, v6 offset:72
    s_mov_b64 exec, -1
    s_mov_b32 s62, 2
L_dma_95:
    s_mov_b32 m0, s61
    s_add_u32 s61, s61, 1024
    buffer_load_dwordx4 v2, s[48:51], s60 offen nt lds
    s_add_u32 s60, s60, 49152
    s_mov_b32 m0, s61
    s_add_u32 s61, s61, 1024
    buffer_load_dwordx4 v2, s[48:51], s60 offen nt lds
    s_add_u32 s60, s60, 49152
    s_mov_b32 m0, s61
    s_add_u32 s61, s61, 1024
    buffer_load_dwordx4 v3, s[48:51], s60 offen nt lds
    s_add_u32 s60, s60, 49152
    s_mov_b32 m0, s61
    s_add_u32 s61, s61, 1024
    buffer_load_dwordx4 v3, s[48:51], s60 offen nt lds
    s_add_u32 s60, s60, 49152
    s_sub_u32 s62, s62, 1
    s_cmp_lg_u32 s62, 0
    s_cbranch_scc1 L_dma_95
    s_waitcnt vmcnt(32)
    v_lshlrev_b32 v32, 16, v8
    v_and_b32 v33, s74, v8
    v_lshlrev_b32 v34, 16, v9
    v_and_b32 v35, s74, v9
    v_lshlrev_b32 v36, 16, v10
    v_and_b32 v37, s74, v10
    v_lshlrev_b32 v38, 16, v11
    v_and_b32 v39, s74, v11
    v_lshlrev_b32 v40, 16, v12
    v_and_b32 v41, s74, v12
    v_lshlrev_b32 v42, 16, v13
    v_and_b32 v43, s74, v13
    v_lshlrev_b32 v44, 16, v14
    v_and_b32 v45, s74, v14
    v_lshlrev_b32 v46, 16, v15
    v_and_b32 v47, s74, v15
    v_mul_f32 v48, 0xbfb8aa3b, v32
    v_mul_f32 v49, 0xbfb8aa3b, v33
    v_mul_f32 v50, 0xbfb8aa3b, v34
    v_mul_f32 v51, 0xbfb8aa3b, v35
    v_mul_f32 v52, 0xbfb8aa3b, v36
    v_mul_f32 v53, 0xbfb8aa3b, v37
    v_mul_f32 v54, 0xbfb8aa3b, v38
    v_mul_f32 v55, 0xbfb8aa3b, v39
    v_mul_f32 v56, 0xbfb8aa3b, v40
    v_mul_f32 v57, 0xbfb8aa3b, v41
    v_mul_f32 v58, 0xbfb8aa3b, v42
    v_mul_f32 v59, 0xbfb8aa3b, v43
    v_mul_f32 v60, 0xbfb8aa3b, v44
    v_mul_f32 v61, 0xbfb8aa3b, v45
    v_mul_f32 v62, 0xbfb8aa3b, v46
    v_mul_f32 v63, 0xbfb8aa3b, v47
    v_exp_f32 v48, v48
    v_exp_f32 v49, v49
    v_exp_f32 v50, v50
    v_exp_f32 v51, v51
    v_exp_f32 v52, v52
    v_exp_f32 v53, v53
    v_exp_f32 v54, v54
    v_exp_f32 v55, v55
    v_exp_f32 v56, v56
    v_exp_f32 v57, v57
    v_exp_f32 v58, v58
    v_exp_f32 v59, v59
    v_exp_f32 v60, v60
    v_exp_f32 v61, v61
    v_exp_f32 v62, v62
    v_exp_f32 v63, v63
    v_add_f32 v48, 1.0, v48
    v_add_f32 v49, 1.0, v49
    v_add_f32 v50, 1.0, v50
    v_add_f32 v51, 1.0, v51
    v_add_f32 v52, 1.0, v52
    v_add_f32 v53, 1.0, v53
    v_add_f32 v54, 1.0, v54
    v_add_f32 v55, 1.0, v55
    v_add_f32 v56, 1.0, v56
    v_add_f32 v57, 1.0, v57
    v_add_f32 v58, 1.0, v58
    v_add_f32 v59, 1.0, v59
    v_add_f32 v60, 1.0, v60
    v_add_f32 v61, 1.0, v61
    v_add_f32 v62, 1.0, v62
    v_add_f32 v63, 1.0, v63
    v_rcp_f32 v48, v48
    v_rcp_f32 v49, v49
    v_rcp_f32 v50, v50
    v_rcp_f32 v51, v51
    v_rcp_f32 v52, v52
    v_rcp_f32 v53, v53
    v_rcp_f32 v54, v54
    v_rcp_f32 v55, v55
    v_rcp_f32 v56, v56
    v_rcp_f32 v57, v57
    v_rcp_f32 v58, v58
    v_rcp_f32 v59, v59
    v_rcp_f32 v60, v60
    v_rcp_f32 v61, v61
    v_rcp_f32 v62, v62
    v_rcp_f32 v63, v63
    v_mul_f32 v32, v32, v48
    v_mul_f32 v33, v33, v49
    v_mul_f32 v34, v34, v50
    v_mul_f32 v35, v35, v51
    v_mul_f32 v36, v36, v52
    v_mul_f32 v37, v37, v53
    v_mul_f32 v38, v38, v54
    v_mul_f32 v39, v39, v55
    v_mul_f32 v40, v40, v56
    v_mul_f32 v41, v41, v57
    v_mul_f32 v42, v42, v58
    v_mul_f32 v43, v43, v59
    v_mul_f32 v44, v44, v60
    v_mul_f32 v45, v45, v61
    v_mul_f32 v46, v46, v62
    v_mul_f32 v47, v47, v63
    v_cvt_pk_bf16_f32 v8, v32, v33
    v_cvt_pk_bf16_f32 v9, v34, v35
    v_cvt_pk_bf16_f32 v10, v36, v37
    v_cvt_pk_bf16_f32 v11, v38, v39
    v_cvt_pk_bf16_f32 v12, v40, v41
    v_cvt_pk_bf16_f32 v13, v42, v43
    v_cvt_pk_bf16_f32 v14, v44, v45
    v_cvt_pk_bf16_f32 v15, v46, v47
    v_lshrrev_b32 v16, 4, v0
    v_lshlrev_b32 v2, 4, v16
    v_bfe_u32 v17, v0, 2, 2
    v_add_u32 v2, v2, v17
    v_lshlrev_b32 v2, 7, v2
    v_and_b32 v16, 1, v16
    v_bfe_u32 v17, v0, 3, 1
    v_lshl_add_u32 v16, v16, 1, v17
    v_xor_b32 v16, s15, v16
    v_lshl_add_u32 v2, v16, 5, v2
    v_and_b32 v16, 3, v0
    v_lshl_add_u32 v2, v16, 3, v2
    v_add_u32 v2, 0x18000, v2
    v_bfe_u32 v28, v0, 2, 2
    v_lshlrev_b32 v28, 5, v28
    v_lshrrev_b32 v29, 5, v0
    v_lshl_add_u32 v28, v29, 4, v28
    v_bfe_u32 v29, v0, 1, 1
    v_lshl_add_u32 v28, v29, 3, v28
    s_lshl_b32 s64, s63, 9
    s_lshl_b32 s61, s15, 7
    s_add_u32 s64, s64, s61
    s_add_u32 s64, s64, 0x4000
    v_mov_b32 v31, s9
    s_mov_b32 s65, 0
    s_waitcnt vmcnt(0)
    s_mov_b64 exec, 1
    ds_add_u32 v4, v5 offset:88
    s_mov_b64 exec, -1
    s_mov_b32 s10, 0
L_fw_96:
    ds_read_b32 v6, v4 offset:88
    s_add_u32 s10, s10, 1
    s_cmp_gt_u32 s10, 800000
    s_cbranch_scc1 L_exit
    s_waitcnt lgkmcnt(0)
    v_cmp_le_u32 vcc, 4, v6
    s_cbranch_vccnz L_fd_97
    s_sleep 1
    s_branch L_fw_96
L_fd_97:
L_mrl:
    ds_read_b64_tr_b16 v[64:65], v2 offset:0
    ds_read_b64_tr_b16 v[66:67], v2 offset:16384
    ds_read_b64_tr_b16 v[68:69], v2 offset:512
    ds_read_b64_tr_b16 v[70:71], v2 offset:16896
    ds_read_b64_tr_b16 v[72:73], v2 offset:1024
    ds_read_b64_tr_b16 v[74:75], v2 offset:17408
    ds_read_b64_tr_b16 v[76:77], v2 offset:1536
    ds_read_b64_tr_b16 v[78:79], v2 offset:17920
    ds_read_b64_tr_b16 v[80:81], v2 offset:8192
    ds_read_b64_tr_b16 v[82:83], v2 offset:24576
    ds_read_b64_tr_b16 v[84:85], v2 offset:8704
    ds_read_b64_tr_b16 v[86:87], v2 offset:25088
    s_waitcnt lgkmcnt(3)
    ds_read_b64_tr_b16 v[88:89], v2 offset:9216
    ds_read_b64_tr_b16 v[90:91], v2 offset:25600
    ds_read_b64_tr_b16 v[92:93], v2 offset:9728
    ds_read_b64_tr_b16 v[94:95], v2 offset:26112
    ds_read_b64_tr_b16 v[96:97], v2 offset:32768
    ds_read_b64_tr_b16 v[98:99], v2 offset:49152
    ds_read_b64_tr_b16 v[100:101], v2 offset:33280
    ds_read_b64_tr_b16 v[102:103], v2 offset:49664
    ds_read_b64_tr_b16 v[104:105], v2 offset:33792
    ds_read_b64_tr_b16 v[106:107], v2 offset:50176
    ds_read_b64_tr_b16 v[108:109], v2 offset:34304
    ds_read_b64_tr_b16 v[110:111], v2 offset:50688
    s_waitcnt lgkmcnt(3)
    ds_read_b64_tr_b16 v[112:113], v2 offset:40960
    ds_read_b64_tr_b16 v[114:115], v2 offset:57344
    ds_read_b64_tr_b16 v[116:117], v2 offset:41472
    ds_read_b64_tr_b16 v[118:119], v2 offset:57856
    ds_read_b64_tr_b16 v[120:121], v2 offset:41984
    ds_read_b64_tr_b16 v[122:123], v2 offset:58368
    ds_read_b64_tr_b16 v[124:125], v2 offset:42496
    ds_read_b64_tr_b16 v[126:127], v2 offset:58880
    s_waitcnt lgkmcnt(0)
    v_mfma_f32_16x16x32_bf16 v[32:35], v[8:11], v[64:67], 0
    v_mfma_f32_16x16x32_bf16 v[36:39], v[8:11], v[68:71], 0
    v_mfma_f32_16x16x32_bf16 v[40:43], v[8:11], v[72:75], 0
    v_mfma_f32_16x16x32_bf16 v[44:47], v[8:11], v[76:79], 0
    v_mfma_f32_16x16x32_bf16 v[48:51], v[8:11], v[80:83], 0
    v_mfma_f32_16x16x32_bf16 v[52:55], v[8:11], v[84:87], 0
    v_mfma_f32_16x16x32_bf16 v[56:59], v[8:11], v[88:91], 0
    v_mfma_f32_16x16x32_bf16 v[60:63], v[8:11], v[92:95], 0
    v_mfma_f32_16x16x32_bf16 v[32:35], v[12:15], v[96:99], v[32:35]
    v_mfma_f32_16x16x32_bf16 v[36:39], v[12:15], v[100:103], v[36:39]
    v_mfma_f32_16x16x32_bf16 v[40:43], v[12:15], v[104:107], v[40:43]
    v_mfma_f32_16x16x32_bf16 v[44:47], v[12:15], v[108:111], v[44:47]
    v_mfma_f32_16x16x32_bf16 v[48:51], v[12:15], v[112:115], v[48:51]
    v_mfma_f32_16x16x32_bf16 v[52:55], v[12:15], v[116:119], v[52:55]
    v_mfma_f32_16x16x32_bf16 v[56:59], v[12:15], v[120:123], v[56:59]
    v_mfma_f32_16x16x32_bf16 v[60:63], v[12:15], v[124:127], v[60:63]
    s_nop 1
    v_add_f32_dpp v26, v32, v38 quad_perm:[0,1,2,3] row_mask:0x1 bank_mask:0xf
    v_add_f32_dpp v27, v33, v39 quad_perm:[0,1,2,3] row_mask:0x1 bank_mask:0xf
    s_nop 0
    v_add_f32_dpp v26, v40, v46 quad_perm:[0,1,2,3] row_mask:0x2 bank_mask:0xf
    v_add_f32_dpp v27, v41, v47 quad_perm:[0,1,2,3] row_mask:0x2 bank_mask:0xf
    s_nop 0
    v_add_f32_dpp v26, v48, v54 quad_perm:[0,1,2,3] row_mask:0x4 bank_mask:0xf
    v_add_f32_dpp v27, v49, v55 quad_perm:[0,1,2,3] row_mask:0x4 bank_mask:0xf
    s_nop 0
    v_add_f32_dpp v26, v56, v62 quad_perm:[0,1,2,3] row_mask:0x8 bank_mask:0xf
    v_add_f32_dpp v27, v57, v63 quad_perm:[0,1,2,3] row_mask:0x8 bank_mask:0xf
    s_nop 1
    v_permlane32_swap_b32 v26, v27
    v_add_f32 v24, v26, v27
    v_mov_b32 v26, v24
    s_nop 1
    v_permlane16_swap_b32 v24, v26
    v_add_f32 v24, v24, v26
    s_nop 1
    v_mov_b32_dpp v26, v24 quad_perm:[1,0,3,2] row_mask:0xf bank_mask:0xf
    v_cvt_pk_bf16_f32 v30, v24, v26
    s_mov_b32 exec_lo, 0x5555
    s_mov_b32 exec_hi, 0x5555
    buffer_store_dwordx2 v[30:31], v28, s[44:47], s64 offen sc1
    s_mov_b64 exec, -1
    v_xor_b32 v2, 64, v2
    s_add_u32 s64, s64, 256
    s_add_u32 s65, s65, 1
    s_cmp_lt_u32 s65, 2
    s_cbranch_scc1 L_mrl
    s_branch L_exit
L_svc:
    s_waitcnt lgkmcnt(0)
    s_mul_i32 s9, s100, 0x85EBCA6B
    s_add_u32 s9, s9, s8
    s_mul_i32 s9, s9, 0x9E3779B1
    s_add_u32 s9, s9, 0x7F4A7C15
    s_getreg_b32 s97, hwreg(HW_REG_XCC_ID)
    s_and_b32 s97, s97, 15
    v_mov_b32 v16, s97
    v_mov_b32 v17, s9
    v_and_b32 v2, 31, v0
    v_lshlrev_b32 v2, 3, v2
    v_lshlrev_b32 v3, 2, v0
    s_lshl_b32 s63, s4, 8
    s_add_u32 s63, s63, 0x1000
    s_lshl_b32 s14, s4, 1
    s_add_u32 s14, s14, s7
    s_lshl_b32 s15, s14, 10
    s_lshl_b32 s14, s14, 11
    s_add_u32 s61, s14, 0x18000
    s_add_u32 s14, s14, 0x8000
    s_lshl_b32 s60, s6, 6
    s_add_u32 s15, s15, s60
    s_add_u32 s15, s15, 0x10000
    s_mov_b32 s96, 0
    s_setprio 2
    s_waitcnt vmcnt(0)
    s_mov_b64 exec, 1
    buffer_store_dwordx2 v[16:17], v4, s[44:47], s64 offen sc1
    s_mov_b64 exec, -1
    s_cmp_ge_u32 s6, s99
    s_cbranch_scc1 L_q0_98
    s_mov_b32 s10, 0
L_fw_100:
    ds_read_b32 v6, v4 offset:72
    s_add_u32 s10, s10, 1
    s_cmp_gt_u32 s10, 800000
    s_cbranch_scc1 L_exit
    s_waitcnt lgkmcnt(0)
    v_cmp_le_u32 vcc, 4, v6
    s_cbranch_vccnz L_fd_101
    s_sleep 2
    s_branch L_fw_100
L_fd_101:
    s_branch L_q1_99
L_q0_98:
    s_and_b32 s60, s6, 12
    s_cmp_eq_u32 s60, 8
    s_cselect_b32 s60, 6, 12
    s_mov_b32 s10, 0
L_fw_102:
    ds_read_b32 v6, v4 offset:16
    s_add_u32 s10, s10, 1
    s_cmp_gt_u32 s10, 800000
    s_cbranch_scc1 L_exit
    s_waitcnt lgkmcnt(0)
    v_cmp_le_u32 vcc, s60, v6
    s_cbranch_vccnz L_fd_103
    s_sleep 4
    s_branch L_fw_102
L_fd_103:
L_q1_99:
    v_lshlrev_b32 v20, 3, v0
    v_not_b32 v11, s9
    s_mov_b32 s10, 0
L_qp_105:
    buffer_load_dwordx4 v[40:43], v1, s[44:47], s14 offen offset:0 sc1
    buffer_load_dwordx4 v[44:47], v1, s[44:47], s14 offen offset:1024 sc1
    s_waitcnt vmcnt(0)
    v_xor_b32 v7, s9, v41
    v_bitop3_b32 v7, v7, v43, s9 bitop3:0xF6
    v_bitop3_b32 v7, v7, v45, s9 bitop3:0xF6
    v_bitop3_b32 v7, v7, v47, s9 bitop3:0xF6
    v_cmp_ne_u32 vcc, 0, v7
    s_cbranch_vccz L_qh_104
    s_sleep 8
    s_add_u32 s10, s10, 1
    s_cmp_gt_u32 s10, 200000
    s_cbranch_scc1 L_exit
    s_cmp_lt_u32 s10, 6
    s_cbranch_scc1 L_qp_105
    s_cmp_lg_u32 s96, 0
    s_cbranch_scc1 L_qp_105
    buffer_load_dwordx2 v[10:11], v2, s[44:47], s63 offen sc1
    s_waitcnt vmcnt(0)
    v_cmp_ne_u32 vcc, s9, v11
    s_cbranch_vccnz L_qp_105
    v_cmp_ne_u32 vcc, s97, v10
    s_nop 0
    s_cmp_eq_u64 vcc, 0
    s_cselect_b32 s96, 2, 1
    v_mov_b32 v10, s96
    s_mov_b64 exec, 1
    ds_add_u32 v4, v10 offset:24
    s_mov_b64 exec, -1
    s_cmp_eq_u32 s96, 1
    s_cselect_b32 s14, s61, s14
    s_branch L_qp_105
L_qh_104:
    ds_write2_b32 v20, v40, v42 offset0:64 offset1:65
    ds_write2_b32 v20, v44, v46 offset0:192 offset1:193
L_qd_106:
    s_mov_b64 exec, 1
    ds_add_u32 v4, v5 offset:20
    s_mov_b64 exec, -1
    s_cmp_lt_u32 s4, 4
    s_cselect_b32 s60, 4, 4
    v_mov_b32 v6, s60
    s_mov_b64 exec, 1
    ds_add_u32 v4, v6 offset:16
    s_mov_b64 exec, -1
    s_mov_b32 s10, 0
    s_cmp_lg_u32 s96, 0
    s_cbranch_scc1 L_xd_109
    v_cmp_ne_u32 vcc, s9, v11
    s_cbranch_vccnz L_xl_108
    v_cmp_ne_u32 vcc, s97, v10
    s_nop 0
    s_cmp_eq_u64 vcc, 0
    s_cselect_b32 s96, 2, 1
    v_mov_b32 v10, s96
    s_mov_b64 exec, 1
    ds_add_u32 v4, v10 offset:24
    s_mov_b64 exec, -1
L_xl_108:
    s_cmp_lg_u32 s96, 0
    s_cbranch_scc1 L_xd_109
    buffer_load_dwordx2 v[10:11], v2, s[44:47], s63 offen sc1
    s_add_u32 s10, s10, 1
    s_cmp_gt_u32 s10, 200000
    s_cbranch_scc1 L_exit
    s_waitcnt vmcnt(0)
    v_cmp_ne_u32 vcc, s9, v11
    s_cbranch_vccnz L_xl_108
    v_cmp_ne_u32 vcc, s97, v10
    s_nop 0
    s_cmp_eq_u64 vcc, 0
    s_cselect_b32 s96, 2, 1
    v_mov_b32 v10, s96
    s_mov_b64 exec, 1
    ds_add_u32 v4, v10 offset:24
    s_mov_b64 exec, -1
L_xd_109:
    s_and_b32 s60, s6, 12
    s_cmp_lg_u32 s60, 8
    s_cbranch_scc1 L_npt
    s_lshl_b32 s60, s4, 3
    s_lshl_b32 s61, s7, 2
    s_add_u32 s60, s60, s61
    s_and_b32 s61, s6, 3
    s_add_u32 s60, s60, s61
    s_lshl_b32 s60, s60, 12
    s_add_u32 s60, s60, 0x20000
    v_lshlrev_b32 v2, 6, v0
    buffer_load_dword v100, v2, s[44:47], s60 offen sc1
L_npt:
    v_lshrrev_b32 v2, 4, v0
    v_lshlrev_b32 v2, 4, v2
    v_mov_b32 v33, s9
    v_mov_b32 v35, s9
    s_mov_b32 s10, 0
L_fw_110:
    ds_read_b32 v6, v4 offset:0
    ds_read_b32 v8, v3 offset:1280
    ds_read_b32 v9, v3 offset:1536
    s_add_u32 s10, s10, 1
    s_cmp_gt_u32 s10, 800000
    s_cbranch_scc1 L_exit
    s_waitcnt lgkmcnt(0)
    v_cmp_le_u32 vcc, 11, v6
    s_cbranch_vccnz L_fd_111
    s_sleep 1
    s_branch L_fw_110
L_fd_111:
    v_mov_b32 v32, v8
    s_nop 1
    v_max_f32_dpp v32, v32, v32 row_ror:1 row_mask:0xf bank_mask:0xf
    s_nop 1
    v_max_f32_dpp v32, v32, v32 row_ror:2 row_mask:0xf bank_mask:0xf
    s_nop 1
    v_max_f32_dpp v32, v32, v32 row_ror:4 row_mask:0xf bank_mask:0xf
    s_nop 1
    v_max_f32_dpp v32, v32, v32 row_ror:8 row_mask:0xf bank_mask:0xf
    v_sub_f32 v8, v8, v32
    v_mul_f32 v8, 0x3fb8aa3b, v8
    v_exp_f32 v8, v8
    s_nop 0
    v_mul_f32 v34, v8, v9
    s_nop 1
    v_add_f32_dpp v34, v34, v34 row_ror:1 row_mask:0xf bank_mask:0xf
    s_nop 1
    v_add_f32_dpp v34, v34, v34 row_ror:2 row_mask:0xf bank_mask:0xf
    s_nop 1
    v_add_f32_dpp v34, v34, v34 row_ror:4 row_mask:0xf bank_mask:0xf
    s_nop 1
    v_add_f32_dpp v34, v34, v34 row_ror:8 row_mask:0xf bank_mask:0xf
    s_mov_b32 exec_lo, 0x10001
    s_mov_b32 exec_hi, 0x10001
    s_cmp_eq_u32 s96, 2
    s_cbranch_scc1 L_pl_112
    buffer_store_dwordx4 v[32:35], v2, s[44:47], s15 offen sc1
    s_branch L_sd_113
L_pl_112:
    buffer_store_dwordx4 v[32:35], v2, s[44:47], s15 offen
L_sd_113:
    s_mov_b64 exec, -1
    s_sub_u32 s63, s6, 8
    s_cmp_lt_u32 s63, 8
    s_cbranch_scc0 L_exit
    s_cmp_lt_u32 s63, 4
    s_cbranch_scc1 L_nxa
    s_mov_b32 s14, 0x1000
    s_mov_b32 s10, 0
    s_branch L_pgo_115
L_poll_114:
    s_sleep 8
L_pgo_115:
    buffer_load_dwordx4 v[16:19], v1, s[44:47], s14 offen offset:0 sc1
    buffer_load_dwordx4 v[20:23], v1, s[44:47], s14 offen offset:1024 sc1
L_pck_116:
    s_add_u32 s10, s10, 1
    s_cmp_gt_u32 s10, 200000
    s_cbranch_scc1 L_exit
    s_waitcnt vmcnt(1)
    v_xor_b32 v7, s9, v17
    v_bitop3_b32 v7, v7, v19, s9 bitop3:0xF6
    s_waitcnt vmcnt(0)
    v_bitop3_b32 v7, v7, v21, s9 bitop3:0xF6
    v_bitop3_b32 v7, v7, v23, s9 bitop3:0xF6
    v_cmp_ne_u32 vcc, 0, v7
    s_cbranch_vccnz L_poll_114
L_nxa:
    s_lshl_b32 s14, s4, 11
    s_add_u32 s14, s14, 0x10000
    v_and_b32 v2, 3, v0
    v_lshlrev_b32 v2, 6, v2
    v_lshrrev_b32 v3, 2, v0
    v_lshl_add_u32 v2, v3, 2, v2
    s_mov_b32 s10, 0
    s_branch L_pgo_118
L_poll_117:
    s_sleep 1
L_pgo_118:
    buffer_load_dwordx4 v[8:11], v1, s[44:47], s14 offen offset:0 sc1
    buffer_load_dwordx4 v[12:15], v1, s[44:47], s14 offen offset:1024 sc1
L_pck_119:
    s_add_u32 s10, s10, 1
    s_cmp_gt_u32 s10, 200000
    s_cbranch_scc1 L_exit
    s_waitcnt vmcnt(1)
    v_xor_b32 v7, s9, v9
    v_bitop3_b32 v7, v7, v11, s9 bitop3:0xF6
    s_waitcnt vmcnt(0)
    v_bitop3_b32 v7, v7, v13, s9 bitop3:0xF6
    v_bitop3_b32 v7, v7, v15, s9 bitop3:0xF6
    v_cmp_ne_u32 vcc, 0, v7
    s_cbranch_vccnz L_poll_117
    s_cmp_lt_u32 s63, 4
    s_cbranch_scc1 L_sw
    s_sleep 25
L_sw:
    s_mov_b64 exec, 1
    ds_add_u32 v4, v5 offset:80
    s_mov_b64 exec, -1
    s_cmp_ge_u32 s63, 4
    s_cbranch_scc1 L_rstd
    v_mov_b32 v16, v8
    v_mov_b32 v20, v12
    s_nop 0
    v_max_f32_dpp v16, v16, v16 row_ror:4 row_mask:0xf bank_mask:0xf
    v_max_f32_dpp v20, v20, v20 row_ror:4 row_mask:0xf bank_mask:0xf
    s_nop 0
    v_max_f32_dpp v16, v16, v16 row_ror:8 row_mask:0xf bank_mask:0xf
    v_max_f32_dpp v20, v20, v20 row_ror:8 row_mask:0xf bank_mask:0xf
    v_mov_b32 v17, v16
    v_mov_b32 v21, v20
    s_nop 0
    v_permlane16_swap_b32 v16, v17
    v_permlane16_swap_b32 v20, v21
    v_max_f32 v16, v16, v17
    v_max_f32 v20, v20, v21
    v_mov_b32 v17, v16
    v_mov_b32 v21, v20
    s_nop 0
    v_permlane32_swap_b32 v16, v17
    v_permlane32_swap_b32 v20, v21
    v_max_f32 v16, v16, v17
    v_max_f32 v20, v20, v21
    v_sub_f32 v16, v8, v16
    v_sub_f32 v20, v12, v20
    v_mul_f32 v16, 0x3fb8aa3b, v16
    v_mul_f32 v20, 0x3fb8aa3b, v20
    v_exp_f32 v16, v16
    v_exp_f32 v20, v20
    v_mul_f32 v18, v16, v10
    v_mul_f32 v22, v20, v14
    s_nop 0
    v_add_f32_dpp v18, v18, v18 row_ror:4 row_mask:0xf bank_mask:0xf
    v_add_f32_dpp v22, v22, v22 row_ror:4 row_mask:0xf bank_mask:0xf
    s_nop 0
    v_add_f32_dpp v18, v18, v18 row_ror:8 row_mask:0xf bank_mask:0xf
    v_add_f32_dpp v22, v22, v22 row_ror:8 row_mask:0xf bank_mask:0xf
    v_mov_b32 v19, v18
    v_mov_b32 v23, v22
    s_nop 0
    v_permlane16_swap_b32 v18, v19
    v_permlane16_swap_b32 v22, v23
    v_add_f32 v18, v18, v19
    v_add_f32 v22, v22, v23
    v_mov_b32 v19, v18
    v_mov_b32 v23, v22
    s_nop 0
    v_permlane32_swap_b32 v18, v19
    v_permlane32_swap_b32 v22, v23
    v_add_f32 v18, v18, v19
    v_add_f32 v22, v22, v23
    v_rcp_f32 v18, v18
    v_rcp_f32 v22, v22
    v_mul_f32 v16, v16, v18
    v_mul_f32 v20, v20, v22
    ds_write2st64_b32 v2, v16, v20 offset0:7 offset1:8
    s_mov_b64 exec, 1
    ds_add_u32 v4, v5 offset:32
    s_mov_b64 exec, -1
    v_lshlrev_b32 v2, 2, v0
    s_lshl_b32 s14, s4, 3
    s_lshl_b32 s15, s7, 2
    s_add_u32 s14, s14, s15
    s_add_u32 s14, s14, s63
    s_lshl_b32 s14, s14, 9
    s_add_u32 s14, s14, 0x80000
    v_and_b32 v2, 31, v0
    v_lshlrev_b32 v2, 4, v2
    v_lshrrev_b32 v3, 5, v0
    v_lshl_add_u32 v24, v3, 15, v2
    v_lshl_add_u32 v3, v3, 11, v2
    v_mov_b32 v2, v24
    s_add_u32 s64, s14, 0
    s_add_u32 s65, s14, 65536
    s_add_u32 s66, s14, 131072
    s_add_u32 s67, s14, 196608
    s_mov_b32 s10, 0
L_fw_120:
    ds_read_b32 v6, v4 offset:44
    s_add_u32 s10, s10, 1
    s_cmp_gt_u32 s10, 800000
    s_cbranch_scc1 L_exit
    s_waitcnt lgkmcnt(0)
    v_cmp_le_u32 vcc, 1, v6
    s_cbranch_vccnz L_fd_121
    s_sleep 1
    s_branch L_fw_120
L_fd_121:
    s_mov_b32 s10, 0
L_fw_122:
    ds_read_b32 v6, v4 offset:44
    ds_read_b128 v[8:11], v3 offset:4096
    ds_read_b128 v[12:15], v3 offset:4608
    ds_read_b128 v[16:19], v3 offset:5120
    ds_read_b128 v[20:23], v3 offset:5632
    s_add_u32 s10, s10, 1
    s_cmp_gt_u32 s10, 800000
    s_cbranch_scc1 L_exit
    s_waitcnt lgkmcnt(0)
    v_cmp_le_u32 vcc, 8, v6
    s_cbranch_vccnz L_fd_123
    s_branch L_fw_122
L_fd_123:
    v_pk_add_f32 v[8:9], v[8:9], v[12:13]
    v_pk_add_f32 v[10:11], v[10:11], v[14:15]
    v_pk_add_f32 v[16:17], v[16:17], v[20:21]
    v_pk_add_f32 v[18:19], v[18:19], v[22:23]
    v_pk_add_f32 v[8:9], v[8:9], v[16:17]
    v_pk_add_f32 v[10:11], v[10:11], v[18:19]
    v_mov_b32 v12, v8
    v_mov_b32 v13, v9
    v_mov_b32 v14, v10
    v_mov_b32 v15, v11
    v_permlane32_swap_b32 v8, v12
    v_permlane32_swap_b32 v9, v13
    v_permlane32_swap_b32 v10, v14
    v_permlane32_swap_b32 v11, v15
    v_pk_add_f32 v[8:9], v[8:9], v[12:13]
    v_pk_add_f32 v[10:11], v[10:11], v[14:15]
    v_min_u32 v8, -2, v8
    v_min_u32 v9, -2, v9
    v_min_u32 v10, -2, v10
    v_min_u32 v11, -2, v11
    buffer_store_dwordx4 v[8:11], v2, s[44:47], s64 offen sc1
    buffer_store_dwordx4 v[8:11], v2, s[44:47], s65 offen sc1
    buffer_store_dwordx4 v[8:11], v2, s[44:47], s66 offen sc1
    buffer_store_dwordx4 v[8:11], v2, s[44:47], s67 offen sc1
    s_branch L_exit
L_rstd:
    s_and_b32 s14, s2, 0x7c
    s_cmp_eq_u32 s14, 0x7c
    s_cbranch_scc1 L_exit
    v_lshlrev_b32 v2, 3, v0
    v_and_b32 v3, 8, v0
    s_mov_b32 s10, 0
L_fw_124:
    ds_read_b32 v6, v4 offset:48
    s_add_u32 s10, s10, 1
    s_cmp_gt_u32 s10, 800000
    s_cbranch_scc1 L_exit
    s_waitcnt lgkmcnt(0)
    v_cmp_le_u32 vcc, 1, v6
    s_cbranch_vccnz L_fd_125
    s_sleep 1
    s_branch L_fw_124
L_fd_125:
    s_mov_b32 s10, 0
L_fw_126:
    ds_read_b32 v6, v4 offset:48
    ds_read_b64 v[32:33], v2 offset:8192
    ds_read_b64 v[34:35], v2 offset:8704
    ds_read_b64 v[36:37], v2 offset:9216
    ds_read_b64 v[38:39], v2 offset:9728
    ds_read_b64 v[40:41], v2 offset:10240
    ds_read_b64 v[42:43], v2 offset:10752
    ds_read_b64 v[44:45], v2 offset:11264
    ds_read_b64 v[46:47], v2 offset:11776
    s_add_u32 s10, s10, 1
    s_cmp_gt_u32 s10, 800000
    s_cbranch_scc1 L_exit
    s_waitcnt lgkmcnt(0)
    v_cmp_le_u32 vcc, 8, v6
    s_cbranch_vccnz L_fd_127
    s_branch L_fw_126
L_fd_127:
    v_pk_add_f32 v[32:33], v[32:33], v[34:35]
    v_pk_add_f32 v[36:37], v[36:37], v[38:39]
    v_pk_add_f32 v[40:41], v[40:41], v[42:43]
    v_pk_add_f32 v[44:45], v[44:45], v[46:47]
    v_pk_add_f32 v[32:33], v[32:33], v[36:37]
    v_pk_add_f32 v[40:41], v[40:41], v[44:45]
    v_pk_add_f32 v[32:33], v[32:33], v[40:41]
    s_nop 1
    v_add_f32_dpp v32, v32, v32 quad_perm:[1,0,3,2] row_mask:0xf bank_mask:0xf
    v_add_f32_dpp v33, v33, v33 quad_perm:[1,0,3,2] row_mask:0xf bank_mask:0xf
    s_nop 0
    v_add_f32_dpp v32, v32, v32 quad_perm:[2,3,0,1] row_mask:0xf bank_mask:0xf
    v_add_f32_dpp v33, v33, v33 quad_perm:[2,3,0,1] row_mask:0xf bank_mask:0xf
    s_nop 0
    v_add_f32_dpp v32, v32, v32 row_half_mirror row_mask:0xf bank_mask:0xf
    v_add_f32_dpp v33, v33, v33 row_half_mirror row_mask:0xf bank_mask:0xf
    v_mov_b32 v34, v32
    v_mov_b32 v35, v33
    s_nop 0
    v_permlane16_swap_b32 v32, v34
    v_permlane16_swap_b32 v33, v35
    v_pk_add_f32 v[32:33], v[32:33], v[34:35]
    v_mov_b32 v34, v32
    v_mov_b32 v35, v33
    s_nop 0
    v_permlane32_swap_b32 v32, v34
    v_permlane32_swap_b32 v33, v35
    v_pk_add_f32 v[32:33], v[32:33], v[34:35]
    v_mul_f32 v19, 0x3b000000, v32
    v_mul_f32 v18, 0x3b000000, v33
    v_fma_f32 v18, -v19, v19, v18
    v_max_f32 v18, 0, v18
    v_cvt_pk_bf16_f32 v18, v18, v18
    v_lshlrev_b32 v18, 16, v18
    v_add_f32 v18, 0x3727c5ac, v18
    v_cvt_pk_bf16_f32 v18, v18, v18
    v_lshlrev_b32 v18, 16, v18
    v_sqrt_f32 v18, v18
    s_nop 0
    v_cvt_pk_bf16_f32 v18, v18, v18
    v_lshlrev_b32 v18, 16, v18
    v_rcp_f32 v18, v18
    s_mov_b64 exec, 0x101
    s_nop 0
    ds_write_b64 v3, v[18:19] offset:2496
    s_mov_b64 exec, 1
    ds_add_u32 v4, v5 offset:84
    s_mov_b64 exec, -1
    s_branch L_exit
L_gl:
    v_lshrrev_b32 v2, 2, v0
    v_and_b32 v3, 3, v0
    s_and_b32 s14, s2, 0x7c
    s_cmp_eq_u32 s14, 0x7c
    s_cbranch_scc1 L_exit
    s_lshl_b32 s15, s4, 1
    s_add_u32 s15, s15, s7
    s_cmp_lt_u32 s4, 4
    s_cselect_b32 s14, 4, 3
    s_mul_i32 s15, s15, s14
    s_cselect_b32 s14, 0, 8
    s_add_u32 s15, s15, s14
    s_add_u32 s15, s15, s6
    s_sub_u32 s15, s15, 12
    s_waitcnt lgkmcnt(0)
    s_mul_i32 s9, s100, 0x85EBCA6B
    s_add_u32 s9, s9, s8
    s_mul_i32 s9, s9, 0x9E3779B1
    s_add_u32 s9, s9, 0x7F4A7C15
    s_mov_b32 s56, s16
    s_and_b32 s57, s17, 0xffff
    s_mov_b32 s58, 0x800
    s_mov_b32 s59, 0x20000
    v_and_b32 v16, 1, v0
    v_lshlrev_b32 v16, 10, v16
    v_lshrrev_b32 v17, 1, v0
    v_lshl_add_u32 v16, v17, 5, v16
    buffer_load_dwordx4 v[32:35], v16, s[56:59], 0 offen
    buffer_load_dwordx4 v[36:39], v16, s[56:59], 0 offen offset:16
    s_mov_b32 s75, 0x3f803f80
    s_waitcnt vmcnt(0)
    v_dot2_f32_bf16 v16, v32, s75, 0
    v_dot2_f32_bf16 v17, v33, s75, 0
    v_dot2_f32_bf16 v16, v34, s75, v16
    v_dot2_f32_bf16 v17, v35, s75, v17
    v_dot2_f32_bf16 v16, v36, s75, v16
    v_dot2_f32_bf16 v17, v37, s75, v17
    v_dot2_f32_bf16 v16, v38, s75, v16
    v_dot2_f32_bf16 v17, v39, s75, v17
    s_nop 2
    v_add_f32 v16, v16, v17
    v_lshlrev_b32 v18, 2, v0
    s_nop 0
    v_add_f32_dpp v16, v16, v16 quad_perm:[2,3,0,1] row_mask:0xf bank_mask:0xf
    s_nop 1
    v_add_f32_dpp v16, v16, v16 row_ror:4 row_mask:0xf bank_mask:0xf
    s_nop 1
    v_add_f32_dpp v16, v16, v16 row_ror:8 row_mask:0xf bank_mask:0xf
    v_mov_b32 v17, v16
    s_nop 1
    v_permlane16_swap_b32 v16, v17
    v_add_f32 v16, v16, v17
    v_mov_b32 v17, v16
    s_nop 1
    v_permlane32_swap_b32 v16, v17
    v_add_f32 v16, v16, v17
    v_mul_f32 v16, 0x3b000000, v16
    s_mov_b64 exec, 3
    ds_write_b32 v18, v16 offset:2528
    s_mov_b64 exec, 1
    ds_add_u32 v4, v5 offset:100
    s_mov_b64 exec, -1
    s_mov_b32 s48, s28
    s_and_b32 s49, s29, 0xffff
    s_mov_b32 s50, 0x1c0000
    s_mov_b32 s51, 0x20000
    s_mov_b32 s52, s30
    s_and_b32 s53, s31, 0xffff
    s_mov_b32 s54, 0x1c0000
    s_mov_b32 s55, 0x20000
    s_mov_b32 s56, s32
    s_and_b32 s57, s33, 0xffff
    s_mov_b32 s58, 0x1c0000
    s_mov_b32 s59, 0x20000
    v_mul_u32_u24 v2, 3584, v2
    v_lshl_add_u32 v2, v3, 4, v2
    v_xor_b32 v3, 16, v2
    v_xor_b32 v8, 32, v2
    v_xor_b32 v9, 48, v2
    s_lshl_b32 s60, s15, 6
    s_mov_b32 s61, 0x18000
    s_mov_b32 s10, 0
L_fw_128:
    ds_read_b32 v6, v4 offset:8
    s_add_u32 s10, s10, 1
    s_cmp_gt_u32 s10, 800000
    s_cbranch_scc1 L_exit
    s_waitcnt lgkmcnt(0)
    v_cmp_le_u32 vcc, 9, v6
    s_cbranch_vccnz L_fd_129
    s_sleep 4
    s_branch L_fw_128
L_fd_129:
    s_mov_b32 s62, 8
L_dma_130:
    s_mov_b32 m0, s61
    s_add_u32 s61, s61, 1024
    buffer_load_dwordx4 v2, s[48:51], s60 offen nt lds
    s_add_u32 s60, s60, 57344
    s_mov_b32 m0, s61
    s_add_u32 s61, s61, 1024
    buffer_load_dwordx4 v3, s[48:51], s60 offen nt lds
    s_add_u32 s60, s60, 57344
    s_mov_b32 m0, s61
    s_add_u32 s61, s61, 1024
    buffer_load_dwordx4 v2, s[48:51], s60 offen nt lds
    s_add_u32 s60, s60, 57344
    s_mov_b32 m0, s61
    s_add_u32 s61, s61, 1024
    buffer_load_dwordx4 v3, s[48:51], s60 offen nt lds
    s_add_u32 s60, s60, 57344
    ds_read_b32 v6, v4 offset:20
    s_waitcnt vmcnt(56) lgkmcnt(0)
    v_cmp_ne_u32 vcc, 0, v6
    s_cbranch_vccnz L_cap_131
    s_waitcnt vmcnt(8)
L_cap_131:
    s_sub_u32 s62, s62, 1
    s_cmp_lg_u32 s62, 0
    s_cbranch_scc1 L_dma_130
    s_lshl_b32 s60, s15, 6
    s_mov_b32 s62, 8
L_dma_132:
    s_mov_b32 m0, s61
    s_add_u32 s61, s61, 1024
    buffer_load_dwordx4 v8, s[52:55], s60 offen nt lds
    s_add_u32 s60, s60, 57344
    s_mov_b32 m0, s61
    s_add_u32 s61, s61, 1024
    buffer_load_dwordx4 v9, s[52:55], s60 offen nt lds
    s_add_u32 s60, s60, 57344
    s_mov_b32 m0, s61
    s_add_u32 s61, s61, 1024
    buffer_load_dwordx4 v8, s[52:55], s60 offen nt lds
    s_add_u32 s60, s60, 57344
    s_mov_b32 m0, s61
    s_add_u32 s61, s61, 1024
    buffer_load_dwordx4 v9, s[52:55], s60 offen nt lds
    s_add_u32 s60, s60, 57344
    ds_read_b32 v6, v4 offset:20
    s_waitcnt vmcnt(56) lgkmcnt(0)
    v_cmp_ne_u32 vcc, 0, v6
    s_cbranch_vccnz L_cap_133
    s_waitcnt vmcnt(8)
L_cap_133:
    s_sub_u32 s62, s62, 1
    s_cmp_lg_u32 s62, 0
    s_cbranch_scc1 L_dma_132
    s_mov_b64 exec, 1
    ds_add_u32 v4, v5 offset:96
    s_mov_b64 exec, -1
    s_mov_b32 s10, 0
L_fw_134:
    ds_read_b32 v6, v4 offset:68
    s_add_u32 s10, s10, 1
    s_cmp_gt_u32 s10, 800000
    s_cbranch_scc1 L_exit
    s_waitcnt lgkmcnt(0)
    v_cmp_le_u32 vcc, 4, v6
    s_cbranch_vccnz L_fd_135
    s_sleep 1
    s_branch L_fw_134
L_fd_135:
    s_mov_b32 s10, 0
L_fw_136:
    ds_read_b32 v6, v4 offset:12
    s_add_u32 s10, s10, 1
    s_cmp_gt_u32 s10, 800000
    s_cbranch_scc1 L_exit
    s_waitcnt lgkmcnt(0)
    v_cmp_le_u32 vcc, 11, v6
    s_cbranch_vccnz L_fd_137
    s_sleep 4
    s_branch L_fw_136
L_fd_137:
    s_lshl_b32 s60, s15, 15
    s_mov_b32 s61, 30720
    s_mov_b32 s62, 8
L_dma_138:
    s_mov_b32 m0, s61
    s_add_u32 s61, s61, 1056
    buffer_load_dwordx4 v1, s[56:59], s60 offen nt lds
    s_add_u32 s60, s60, 1024
    s_mov_b32 m0, s61
    s_add_u32 s61, s61, 1056
    buffer_load_dwordx4 v1, s[56:59], s60 offen nt lds
    s_add_u32 s60, s60, 1024
    s_mov_b32 m0, s61
    s_add_u32 s61, s61, 1056
    buffer_load_dwordx4 v1, s[56:59], s60 offen nt lds
    s_add_u32 s60, s60, 1024
    s_mov_b32 m0, s61
    s_add_u32 s61, s61, 1056
    buffer_load_dwordx4 v1, s[56:59], s60 offen nt lds
    s_add_u32 s60, s60, 1024
    s_waitcnt vmcnt(56)
    s_sub_u32 s62, s62, 1
    s_cmp_lg_u32 s62, 0
    s_cbranch_scc1 L_dma_138
    s_waitcnt vmcnt(32)
    s_mov_b64 exec, 1
    ds_add_u32 v4, v5 offset:36
    s_mov_b64 exec, -1
    s_waitcnt vmcnt(0)
    s_mov_b64 exec, 1
    ds_add_u32 v4, v5 offset:40
    s_mov_b64 exec, -1
    s_cmp_ge_u32 s6, 14
    s_cbranch_scc1 L_exit
    s_lshl_b32 s14, s4, 2
    s_lshl_b32 s61, s7, 1
    s_add_u32 s14, s14, s61
    s_add_u32 s14, s14, s6
    s_sub_u32 s14, s14, 12
    s_mov_b32 s48, s38
    s_and_b32 s49, s39, 0xffff
    s_mov_b32 s50, 0x800
    s_mov_b32 s51, 0x20000
    v_lshrrev_b32 v16, 5, v0
    v_bfe_u32 v17, v0, 4, 1
    v_bfe_u32 v18, v0, 1, 2
    v_and_b32 v19, 1, v0
    v_lshlrev_b32 v2, 5, v18
    v_lshl_add_u32 v2, v16, 4, v2
    v_lshl_add_u32 v3, v19, 2, v2
    v_lshl_add_u32 v3, v17, 1, v3
    v_lshl_add_u32 v2, v19, 3, v2
    s_lshr_b32 s60, s14, 4
    s_lshl_b32 s60, s60, 10
    s_bfe_u32 s61, s14, 0x10003
    s_lshl_b32 s61, s61, 3
    s_add_u32 s60, s60, s61
    s_bfe_u32 s61, s14, 0x10002
    s_lshl_b32 s61, s61, 7
    s_add_u32 s60, s60, s61
    s_and_b32 s61, s14, 3
    s_lshl_b32 s61, s61, 8
    s_add_u32 s60, s60, s61
    v_add_u32 v3, s60, v3
    v_and_b32 v20, 7, v0
    v_lshlrev_b32 v20, 2, v20
    v_lshl_add_u32 v20, v17, 1, v20
    v_lshl_add_u32 v20, v16, 10, v20
    s_lshl_b32 s65, s14, 5
    v_cmp_eq_u32 s[66:67], 1, v17
    s_lshl_b32 s60, s14, 7
    s_add_u32 s60, s60, 0x7000
    s_lshl_b32 s68, s14, 13
    s_add_u32 s68, s68, 0xc0000
    s_add_u32 s69, s68, 4096
    v_mov_b32 v31, s9
    s_mov_b32 s10, 0
    s_branch L_pgo_140
L_poll_139:
    s_sleep 2
L_pgo_140:
    buffer_load_dwordx2 v[8:9], v2, s[44:47], s60 offen sc1
L_pck_141:
    s_add_u32 s10, s10, 1
    s_cmp_gt_u32 s10, 200000
    s_cbranch_scc1 L_exit
    s_waitcnt vmcnt(0)
    v_xor_b32 v7, s9, v9
    v_cmp_ne_u32 vcc, 0, v7
    s_cbranch_vccnz L_poll_139
    v_lshlrev_b32 v21, 16, v8
    v_and_b32 v8, s74, v8
    v_cndmask_b32 v21, v21, v8, s[66:67]
    s_mov_b32 s10, 0
L_fw_142:
    ds_read_b32 v6, v4 offset:48
    ds_read_u16 v22, v3 offset:4096
    s_add_u32 s10, s10, 1
    s_cmp_gt_u32 s10, 800000
    s_cbranch_scc1 L_exit
    s_waitcnt lgkmcnt(0)
    v_cmp_le_u32 vcc, 8, v6
    s_cbranch_vccnz L_fd_143
    s_sleep 2
    s_branch L_fw_142
L_fd_143:
    v_lshlrev_b32 v22, 16, v22
    s_mov_b32 s10, 0
L_fw_144:
    ds_read_b32 v6, v4 offset:56
    s_add_u32 s10, s10, 1
    s_cmp_gt_u32 s10, 800000
    s_cbranch_scc1 L_exit
    s_waitcnt lgkmcnt(0)
    v_cmp_le_u32 vcc, 1, v6
    s_cbranch_vccnz L_fd_145
    s_branch L_fw_144
L_fd_145:
    s_mov_b32 s10, 0
L_poll_146:
    buffer_load_dwordx4 v[32:35], v1, s[44:47], s68 offen offset:0 sc1
    buffer_load_dwordx4 v[36:39], v1, s[44:47], s68 offen offset:1024 sc1
    buffer_load_dwordx4 v[40:43], v1, s[44:47], s68 offen offset:2048 sc1
    buffer_load_dwordx4 v[44:47], v1, s[44:47], s68 offen offset:3072 sc1
    buffer_load_dwordx4 v[48:51], v1, s[44:47], s69 offen offset:0 sc1
    buffer_load_dwordx4 v[52:55], v1, s[44:47], s69 offen offset:1024 sc1
    buffer_load_dwordx4 v[56:59], v1, s[44:47], s69 offen offset:2048 sc1
L_pck_148:
    s_add_u32 s10, s10, 1
    s_cmp_gt_u32 s10, 200000
    s_cbranch_scc1 L_exit
    s_waitcnt vmcnt(6)
    v_max_u32 v7, v32, v33
    v_max3_u32 v7, v7, v34, v35
    s_waitcnt vmcnt(5)
    v_max3_u32 v7, v7, v36, v37
    v_max3_u32 v7, v7, v38, v39
    v_pk_add_f32 v[16:17], v[32:33], v[36:37]
    v_pk_add_f32 v[18:19], v[34:35], v[38:39]
    s_waitcnt vmcnt(4)
    v_max3_u32 v7, v7, v40, v41
    v_max3_u32 v7, v7, v42, v43
    v_pk_add_f32 v[16:17], v[16:17], v[40:41]
    v_pk_add_f32 v[18:19], v[18:19], v[42:43]
    s_waitcnt vmcnt(3)
    v_max3_u32 v7, v7, v44, v45
    v_max3_u32 v7, v7, v46, v47
    v_pk_add_f32 v[16:17], v[16:17], v[44:45]
    v_pk_add_f32 v[18:19], v[18:19], v[46:47]
    s_waitcnt vmcnt(2)
    v_max3_u32 v7, v7, v48, v49
    v_max3_u32 v7, v7, v50, v51
    v_pk_add_f32 v[16:17], v[16:17], v[48:49]
    v_pk_add_f32 v[18:19], v[18:19], v[50:51]
    s_waitcnt vmcnt(1)
    v_max3_u32 v7, v7, v52, v53
    v_max3_u32 v7, v7, v54, v55
    v_pk_add_f32 v[16:17], v[16:17], v[52:53]
    v_pk_add_f32 v[18:19], v[18:19], v[54:55]
    s_waitcnt vmcnt(0)
    v_max3_u32 v7, v7, v56, v57
    v_max3_u32 v7, v7, v58, v59
    v_pk_add_f32 v[16:17], v[16:17], v[56:57]
    v_pk_add_f32 v[18:19], v[18:19], v[58:59]
    v_cmp_eq_u32 vcc, -1, v7
    s_cbranch_vccnz L_poll_146
    v_permlane32_swap_b32 v16, v17
    v_permlane32_swap_b32 v18, v19
    v_add_f32 v16, v16, v17
    v_add_f32 v18, v18, v19
    s_nop 1
    v_permlane16_swap_b32 v16, v18
    v_add_f32 v16, v16, v18
    s_nop 1
    v_add_f32_dpp v16, v16, v16 row_ror:8 row_mask:0xf bank_mask:0xf
    v_cvt_pk_bf16_f32 v16, v16, v16
    v_lshlrev_b32 v16, 16, v16
    v_mul_f32 v16, v21, v16
    v_cvt_pk_bf16_f32 v16, v16, v16
    v_lshlrev_b32 v16, 16, v16
    v_add_f32 v16, v22, v16
    v_cvt_pk_bf16_f32 v16, v16, v16
    s_mov_b32 exec_lo, 0x00ff00ff
    s_mov_b32 exec_hi, 0x00ff00ff
    buffer_store_short v16, v20, s[48:51], s65 offen
    s_mov_b64 exec, 1
    s_cmp_lg_u32 s14, 0
    s_cbranch_scc1 L_exit
    s_add_u32 s8, s8, 1
    s_add_u32 s100, s100, 1
    s_mov_b32 s60, 0xffe00
    v_mov_b32 v30, s8
    v_mov_b32 v31, s100
    buffer_store_dword v30, v4, s[44:47], 0 offen offset:0 sc1
    buffer_store_dword v31, v4, s[44:47], s60 offen sc1
    s_branch L_exit
L_exit:
L_end:
    s_endpgm
    s_endpgm
    s_endpgm
    s_endpgm
    s_endpgm
    s_endpgm
    s_endpgm
    s_endpgm
    s_endpgm
    s_endpgm
    s_endpgm
    s_endpgm
    s_endpgm
    s_endpgm
    s_endpgm
    s_endpgm
    s_endpgm
    s_endpgm
    s_endpgm
    s_endpgm
    s_endpgm
    s_endpgm
    s_endpgm
    s_endpgm
    s_endpgm
    s_endpgm
    s_endpgm
    s_endpgm
    s_endpgm
    s_endpgm
    s_endpgm
    s_endpgm
    s_endpgm
    s_endpgm
    s_endpgm
    s_endpgm
    s_endpgm
    s_endpgm
    s_endpgm
    s_endpgm
    s_endpgm
    s_endpgm
    s_endpgm
    s_endpgm
    s_endpgm
    s_endpgm
    s_endpgm
    s_endpgm
    s_endpgm
    s_endpgm
    s_endpgm
    s_endpgm
    s_endpgm
    s_endpgm
    s_endpgm
    s_endpgm
    s_endpgm
    s_endpgm
    s_endpgm
    s_endpgm
    s_endpgm
    s_endpgm
    s_endpgm
    s_endpgm
    s_endpgm
    s_endpgm
    s_endpgm
L_codeend:

.section .rodata,"a"
.p2align 6
.amdhsa_kernel adaLN_cond__sliding_block_cached__swiglu_ffn__decode_kernel
  .amdhsa_next_free_vgpr 168
  .amdhsa_next_free_sgpr 102
  .amdhsa_accum_offset 168
  .amdhsa_group_segment_fixed_size 0
  .amdhsa_kernarg_size 112
  .amdhsa_user_sgpr_count 2
  .amdhsa_user_sgpr_kernarg_segment_ptr 1
  .amdhsa_system_sgpr_workgroup_id_x 1
  .amdhsa_float_denorm_mode_32 3
  .amdhsa_float_denorm_mode_16_64 3
.end_amdhsa_kernel
```
